```python
import torch

def _softmax(x, axis=-1):
    return torch.softmax(x, dim=axis)
def _gelu(x):
    return torch.nn.functional.gelu(x, approximate="tanh")
def _silu(x):
    return torch.nn.functional.silu(x)
def _sigmoid(x):
    return torch.sigmoid(x)
def _layernorm(x, axis=-1, eps=1e-5):
    m = x.mean(dim=axis, keepdim=True)
    v = x.var(dim=axis, keepdim=True, unbiased=False)
    return (x - m) / torch.sqrt(v + eps)
def _scatter_add(tgt, idx, src, axis=0):
    return tgt.clone().index_add_(axis, idx, src)
def _segment_sum(src, seg, n):
    out = torch.zeros((n,) + src.shape[1:], dtype=src.dtype)
    return out.index_add_(0, seg, src)
def _pad(x, pw):
    flat = tuple(v for pair in reversed(pw) for v in pair)
    return torch.nn.functional.pad(x, flat)

kernel_name = 'sequential_preLN__ssm_conv_h3__glu_gated_geglu__prompt'

def setup_inputs():

    _w = (lambda a: (lambda t: t.to(torch.bfloat16) if t.is_floating_point() else t)(torch.as_tensor(a)))
    def _A_setup():
        B, S, D = 1, 2048, 512
        ks = 4
        return {
            "q": _w((lambda *s: torch.randn(*s, dtype=torch.bfloat16) * 0.05)(B, S, D)),
            "k": _w((lambda *s: torch.randn(*s, dtype=torch.bfloat16) * 0.2)(B, S, D)),
            "v": _w((lambda *s: torch.randn(*s, dtype=torch.bfloat16) * 0.2)(B, S, D)),
            "shift_k": _w((lambda *s: torch.randn(*s, dtype=torch.bfloat16) * 0.2)(D, ks) * 0.5),
            "ssm_k": _w((lambda *s: torch.randn(*s, dtype=torch.bfloat16) * 0.4)(D, S) * (1.0 / S ** 0.5)),
            "ssm_D": _w((lambda *s: torch.randn(*s, dtype=torch.bfloat16) * 0.2)(D)),
        }
    _A_in = _A_setup()

    def _B_setup():
        B, S, Dm, Df = 1, 2048, 512, 1792
        return {
            "x": _w((lambda *s: torch.randn(*s, dtype=torch.bfloat16) * 0.05)(B, S, Dm)),
            "w_gate": _w((lambda *s: torch.randn(*s, dtype=torch.bfloat16) * 0.4)(Dm, Df) * (Dm ** -0.5)),
            "w_up": _w((lambda *s: torch.randn(*s, dtype=torch.bfloat16) * 0.4)(Dm, Df) * (Dm ** -0.5)),
            "w_down": _w((lambda *s: torch.randn(*s, dtype=torch.bfloat16) * 0.4)(Df, Dm) * (Df ** -0.5)),
        }
    _B_in = _B_setup()

    return {
        "A_q": _A_in["q"],
        "A_k": _A_in["k"],
        "A_v": _A_in["v"],
        "A_shift_k": _A_in["shift_k"],
        "A_ssm_k": _A_in["ssm_k"],
        "A_ssm_D": _A_in["ssm_D"],
        "B_x": _B_in["x"],
        "B_w_gate": _B_in["w_gate"],
        "B_w_up": _B_in["w_up"],
        "B_w_down": _B_in["w_down"],
    }

def reference(A_q, A_k, A_v, A_shift_k, A_ssm_k, A_ssm_D, B_x, B_w_gate, B_w_up, B_w_down):
    def _A_ref(q, k, v, shift_k, ssm_k, ssm_D):
        B, S, D = q.shape
        ks = shift_k.shape[-1]
        k_pad = _pad(k, ((0, 0), (ks - 1, 0), (0, 0)))
        k_shift = torch.zeros_like(k)
        for t in range(ks):
            k_shift = k_shift + k_pad[:, t:t + S, :] * shift_k[:, ks - 1 - t][None, None, :]
        kv = k_shift * v
        L = 2 * S
        kv_pad = _pad(kv, ((0, 0), (0, S), (0, 0)))
        kf_pad = _pad(ssm_k, ((0, 0), (0, S)))
        kv_f = (lambda x, axes=(-2,-1): torch.fft.rfft2(x.float(), dim=axes))(kv_pad[:, None, :, :], axes=(1, 2))
        kf_f = (lambda x, axes=(-2,-1): torch.fft.rfft2(x.float(), dim=axes))(kf_pad[:, None, :], axes=(1, 2))
        kf_f = (lambda x, *d: x.permute(*d))(kf_f, 1, 2, 0)
        y_f = kv_f * kf_f[None, :, :, :]
        y = (lambda x, s, axes=(-2,-1): torch.fft.irfft2(x, s=s, dim=axes).to(torch.bfloat16))(y_f, (1, L), axes=(1, 2))[:, 0, :S, :]
        y = y + kv * ssm_D[None, None, :]
        return q * y

    def _B_ref(x, w_gate, w_up, w_down):
        g = torch.einsum("bsd,df->bsf", x, w_gate)
        u = torch.einsum("bsd,df->bsf", x, w_up)
        h = _gelu(g) * u
        return torch.einsum("bsf,fd->bsd", h, w_down)

    x = A_q
    h = x + _A_ref(_layernorm(x, axis=-1), A_k, A_v, A_shift_k, A_ssm_k, A_ssm_D)
    h2 = h + _B_ref(_layernorm(h, axis=-1), B_w_gate, B_w_up, B_w_down)
    return h2
```

```asm
; @launch kernel=a_kernel grid=(256,1,1) block=(256,1,1) lds=112144
; @launch kernel=g_kernel grid=(256,1,1) block=(256,1,1) lds=131072
.amdgcn_target "amdgcn-amd-amdhsa--gfx950"
.text
.globl a_kernel
.p2align 8
.type a_kernel,@function
a_kernel:
    s_cmp_ge_u32 s2, 256
    s_cbranch_scc1 a_end
    s_load_dwordx2 s[12:13], s[0:1], 96
    v_and_b32 v1, 63, v0
    v_lshrrev_b32 v2, 6, v0
    s_nop 0
    v_readfirstlane_b32 s44, v2
    s_setprio 3
    s_load_dwordx4 s[4:7], s[0:1], 0
    s_load_dwordx4 s[8:11], s[0:1], 16
    s_load_dwordx4 s[64:67], s[0:1], 32
    s_load_dwordx2 s[14:15], s[0:1], 88
    s_lshr_b32 s45, s2, 3
    s_and_b32 s46, s2, 7
    v_bfe_u32 v3, v1, 4, 2
    v_lshlrev_b32 v3, 1, v3
    v_and_b32 v2, 7, v1
    v_xor_b32 v2, v2, v3
    v_lshlrev_b32 v2, 4, v2
    v_lshrrev_b32 v3, 3, v1
    v_lshl_add_u32 v2, v3, 10, v2
    s_lshl_b32 s52, s45, 16
    s_lshl_b32 s53, s46, 7
    s_add_u32 s52, s52, s53
    v_add_u32 v2, s52, v2
    s_lshl_b32 s53, s44, 14
    v_add_u32 v3, s53, v2
    v_subrev_u32 v4, 8192, v2
    s_cmp_eq_u32 s45, 0
    s_cselect_b32 s53, 0x80000000, 0
    v_or_b32 v4, s53, v4
    s_lshl_b32 s47, s46, 5
    s_add_u32 s47, s47, s45
    s_lshr_b32 s48, s44, 1
    s_and_b32 s49, s44, 1
    s_lshl_b32 s50, s47, 1
    s_add_u32 s50, s50, s48
    s_lshl_b32 s50, s50, 12
    v_and_b32 v5, 15, v1
    s_lshl_b32 s54, s46, 6
    s_lshl_b32 s55, s44, 4
    s_add_u32 s54, s54, s55
    v_add_u32 v5, s54, v5
    v_lshlrev_b32 v6, 3, v5
    s_lshl_b32 s56, s44, 11
    s_mov_b32 s57, 8192
    s_waitcnt lgkmcnt(0)
    s_cmp_lg_u32 s2, 0
    s_cbranch_scc1 a_nononce
    s_cmp_lg_u32 s44, 0
    s_cbranch_scc1 a_nononce
    s_memrealtime s[52:53]
    v_mov_b32 v10, 0
    s_waitcnt lgkmcnt(0)
    s_or_b32 s52, s52, 1
    v_mov_b32 v11, s52
    s_mov_b64 exec, 1
    global_store_dword v10, v11, s[14:15] sc1
    s_mov_b64 exec, -1
a_nononce:
    s_cmp_lg_u32 s2, 0
    s_cbranch_scc1 a_nocnt
    s_add_u32 s54, s12, 6488064
    s_addc_u32 s55, s13, 0
    v_and_b32 v10, 31, v1
    v_lshlrev_b32 v10, 8, v10
    v_mov_b32 v11, 0
    global_store_dword v10, v11, s[54:55]
a_nocnt:
    s_mov_b32 s20, s6
    s_mov_b32 s21, s7
    s_mov_b32 s22, 2097152
    s_mov_b32 s23, 131072
    s_mov_b32 s24, s8
    s_mov_b32 s25, s9
    s_mov_b32 s26, 2097152
    s_mov_b32 s27, 131072
    s_add_u32 s54, s56, 34304
    s_mov_b32 m0, s54
    s_add_u32 s55, s54, 1024
    buffer_load_dwordx4 v3, s[20:23], 0 offen lds
    s_mov_b32 m0, s55
    s_add_u32 s54, s56, 42496
    buffer_load_dwordx4 v3, s[20:23], s57 offen lds
    s_mov_b32 m0, s54
    s_add_u32 s55, s54, 1024
    buffer_load_dwordx4 v3, s[24:27], 0 offen lds
    s_mov_b32 m0, s55
    s_mov_b32 s28, s10
    buffer_load_dwordx4 v3, s[24:27], s57 offen lds
    s_mov_b32 m0, 33280
    s_mov_b32 s29, s11
    s_mov_b32 s30, 4096
    s_mov_b32 s31, 131072
    buffer_load_dwordx4 v4, s[20:23], 0 offen lds
    buffer_load_dwordx2 v[44:45], v6, s[28:31], 0 offen
    s_mov_b32 s60, s64
    s_mov_b32 s61, s65
    s_mov_b32 s62, 2097152
    s_mov_b32 s63, 131072
    s_lshl_b32 s52, s49, 7
    v_add_u32 v7, s52, v1
    v_lshlrev_b32 v129, 4, v7
    v_add_u32 v8, s50, v129
    v_subrev_u32 v9, 16, v8
    v_mov_b32 v10, 0x80000000
    v_cmp_eq_u32 vcc, 0, v7
    s_nop 1
    v_cndmask_b32 v10, v9, v10, vcc
    v_add_u32 v9, 1024, v9
    buffer_load_dwordx4 v[112:115], v10, s[60:63], 0 offen
    buffer_load_dwordx4 v[116:119], v8, s[60:63], 0 offen
    buffer_load_dwordx4 v[120:123], v9, s[60:63], 0 offen
    buffer_load_dwordx4 v[124:127], v8, s[60:63], 0 offen offset:1024
    s_mov_b32 s16, s4
    s_mov_b32 s17, s5
    s_mov_b32 s18, 2097152
    s_mov_b32 s19, 131072
    s_mov_b32 s68, s66
    s_mov_b32 s69, s67
    s_mov_b32 s70, 1024
    s_mov_b32 s71, 131072
    s_mov_b32 s32, s12
    s_mov_b32 s33, s13
    s_mov_b32 s34, 2097152
    s_mov_b32 s35, 131072
    s_add_u32 s36, s12, 2097152
    s_addc_u32 s37, s13, 0
    s_mov_b32 s38, 2097152
    s_mov_b32 s39, 131072
    s_add_u32 s40, s12, 6291456
    s_addc_u32 s41, s13, 0
    s_mov_b32 s42, 16384
    s_mov_b32 s43, 131072
    v_bfe_u32 v7, v1, 2, 2
    v_lshrrev_b32 v8, 4, v1
    v_lshl_add_u32 v9, v8, 4, v7
    v_lshlrev_b32 v9, 7, v9
    v_and_b32 v11, 1, v1
    v_lshl_add_u32 v9, v11, 3, v9
    v_bfe_u32 v11, v1, 1, 1
    s_lshl_b32 s54, s44, 1
    v_or_b32 v11, s54, v11
    v_lshrrev_b32 v7, 1, v7
    v_lshlrev_b32 v7, 1, v7
    v_xor_b32 v12, v11, v7
    v_lshl_add_u32 v12, v12, 4, v9
    v_xor_b32 v7, 4, v7
    v_xor_b32 v13, v11, v7
    v_lshl_add_u32 v13, v13, 4, v9
    v_and_b32 v7, 7, v1
    s_lshl_b32 s54, s46, 6
    s_lshl_b32 s55, s44, 4
    s_add_u32 s54, s54, s55
    v_add_u32 v7, s54, v7
    v_lshlrev_b32 v7, 12, v7
    v_bfe_u32 v9, v1, 3, 1
    v_lshl_add_u32 v7, v9, 4, v7
    s_lshl_b32 s54, s45, 7
    v_lshl_add_u32 v16, v8, 5, v7
    v_add_u32 v16, s54, v16
    s_sub_u32 s54, 4064, s54
    v_lshlrev_b32 v9, 5, v8
    v_sub_u32 v15, v7, v9
    v_add_u32 v15, s54, v15
    s_mov_b32 s58, 32768
    v_mov_b32 v7, 58884
    v_mov_b32 v9, 0
    ds_write_b32 v7, v9
    s_waitcnt vmcnt(4) lgkmcnt(0)
    s_barrier
    s_lshl_b32 s52, s45, 6
    s_lshl_b32 s53, s46, 3
    s_add_u32 s52, s52, s53
    s_lshl_b32 s53, s44, 1
    s_add_u32 s51, s52, s53
    s_lshl_b32 s52, s51, 10
    v_lshlrev_b32 v10, 4, v1
    v_add_u32 v10, s52, v10
    buffer_load_dwordx4 v[48:51], v10, s[16:19], 0 offen
    buffer_load_dwordx4 v[52:55], v10, s[16:19], 0 offen offset:1024
    s_add_u32 s54, s56, 50688
    s_mov_b32 m0, s54
    s_add_u32 s55, s54, 1024
    buffer_load_dwordx4 v3, s[16:19], 0 offen lds
    s_mov_b32 m0, s55
    s_lshr_b32 s52, s50, 11
    buffer_load_dwordx4 v3, s[16:19], s57 offen lds
    s_and_b32 s52, s52, 0xfffffffc
    v_mov_b32 v10, s52
    buffer_load_dword v131, v10, s[68:71], 0 offen
    v_mov_b32 v14, 0
    global_load_dword v130, v14, s[14:15] sc1
    ds_read_b64_tr_b16 v[20:21], v13 offset:33792
    ds_read_b64_tr_b16 v[22:23], v12 offset:34304
    ds_read_b64_tr_b16 v[24:25], v13 offset:34816
    ds_read_b64_tr_b16 v[26:27], v12 offset:35328
    ds_read_b64_tr_b16 v[28:29], v13 offset:35840
    ds_read_b64_tr_b16 v[30:31], v12 offset:42496
    ds_read_b64_tr_b16 v[32:33], v13 offset:43008
    ds_read_b64_tr_b16 v[34:35], v12 offset:43520
    ds_read_b64_tr_b16 v[36:37], v13 offset:44032
    v_lshlrev_b32 v40, 16, v44
    v_and_b32 v41, 0xffff0000, v44
    v_lshlrev_b32 v42, 16, v45
    v_and_b32 v43, 0xffff0000, v45
    s_waitcnt lgkmcnt(4)
    v_lshlrev_b32 v70, 16, v20
    v_and_b32 v71, 0xffff0000, v20
    v_lshlrev_b32 v72, 16, v21
    v_and_b32 v73, 0xffff0000, v21
    v_lshlrev_b32 v74, 16, v22
    v_and_b32 v75, 0xffff0000, v22
    v_lshlrev_b32 v76, 16, v23
    v_and_b32 v77, 0xffff0000, v23
    v_lshlrev_b32 v78, 16, v24
    v_and_b32 v79, 0xffff0000, v24
    v_lshlrev_b32 v80, 16, v25
    v_and_b32 v81, 0xffff0000, v25
    v_lshlrev_b32 v82, 16, v26
    v_and_b32 v83, 0xffff0000, v26
    v_lshlrev_b32 v84, 16, v27
    v_and_b32 v85, 0xffff0000, v27
    v_lshlrev_b32 v86, 16, v28
    v_and_b32 v87, 0xffff0000, v28
    v_lshlrev_b32 v88, 16, v29
    v_and_b32 v89, 0xffff0000, v29
    v_mul_f32 v92, v43, v71
    v_mul_f32 v93, v43, v72
    v_mul_f32 v94, v43, v73
    v_mul_f32 v95, v43, v74
    v_mul_f32 v96, v43, v75
    v_mul_f32 v97, v43, v76
    v_mul_f32 v98, v43, v77
    v_mul_f32 v99, v43, v78
    v_mul_f32 v100, v43, v79
    v_mul_f32 v101, v43, v80
    v_mul_f32 v102, v43, v81
    v_mul_f32 v103, v43, v82
    v_mul_f32 v104, v43, v83
    v_mul_f32 v105, v43, v84
    v_mul_f32 v106, v43, v85
    v_mul_f32 v107, v43, v86
    v_fmac_f32 v92, v42, v72
    v_fmac_f32 v93, v42, v73
    v_fmac_f32 v94, v42, v74
    v_fmac_f32 v95, v42, v75
    v_fmac_f32 v96, v42, v76
    v_fmac_f32 v97, v42, v77
    v_fmac_f32 v98, v42, v78
    v_fmac_f32 v99, v42, v79
    v_fmac_f32 v100, v42, v80
    v_fmac_f32 v101, v42, v81
    v_fmac_f32 v102, v42, v82
    v_fmac_f32 v103, v42, v83
    v_fmac_f32 v104, v42, v84
    v_fmac_f32 v105, v42, v85
    v_fmac_f32 v106, v42, v86
    v_fmac_f32 v107, v42, v87
    v_fmac_f32 v92, v41, v73
    v_fmac_f32 v93, v41, v74
    v_fmac_f32 v94, v41, v75
    v_fmac_f32 v95, v41, v76
    v_fmac_f32 v96, v41, v77
    v_fmac_f32 v97, v41, v78
    v_fmac_f32 v98, v41, v79
    v_fmac_f32 v99, v41, v80
    v_fmac_f32 v100, v41, v81
    v_fmac_f32 v101, v41, v82
    v_fmac_f32 v102, v41, v83
    v_fmac_f32 v103, v41, v84
    v_fmac_f32 v104, v41, v85
    v_fmac_f32 v105, v41, v86
    v_fmac_f32 v106, v41, v87
    v_fmac_f32 v107, v41, v88
    v_fmac_f32 v92, v40, v74
    v_fmac_f32 v93, v40, v75
    v_fmac_f32 v94, v40, v76
    v_fmac_f32 v95, v40, v77
    v_fmac_f32 v96, v40, v78
    v_fmac_f32 v97, v40, v79
    v_fmac_f32 v98, v40, v80
    v_fmac_f32 v99, v40, v81
    v_fmac_f32 v100, v40, v82
    v_fmac_f32 v101, v40, v83
    v_fmac_f32 v102, v40, v84
    v_fmac_f32 v103, v40, v85
    v_fmac_f32 v104, v40, v86
    v_fmac_f32 v105, v40, v87
    v_fmac_f32 v106, v40, v88
    v_fmac_f32 v107, v40, v89
    s_waitcnt lgkmcnt(0)
    v_lshlrev_b32 v18, 16, v30
    v_and_b32 v19, 0xffff0000, v30
    v_mul_f32 v92, v92, v18
    v_mul_f32 v93, v93, v19
    v_lshlrev_b32 v18, 16, v31
    v_and_b32 v19, 0xffff0000, v31
    v_mul_f32 v94, v94, v18
    v_mul_f32 v95, v95, v19
    v_lshlrev_b32 v18, 16, v32
    v_and_b32 v19, 0xffff0000, v32
    v_mul_f32 v96, v96, v18
    v_mul_f32 v97, v97, v19
    v_lshlrev_b32 v18, 16, v33
    v_and_b32 v19, 0xffff0000, v33
    v_mul_f32 v98, v98, v18
    v_mul_f32 v99, v99, v19
    v_lshlrev_b32 v18, 16, v34
    v_and_b32 v19, 0xffff0000, v34
    v_mul_f32 v100, v100, v18
    v_mul_f32 v101, v101, v19
    v_lshlrev_b32 v18, 16, v35
    v_and_b32 v19, 0xffff0000, v35
    v_mul_f32 v102, v102, v18
    v_mul_f32 v103, v103, v19
    v_lshlrev_b32 v18, 16, v36
    v_and_b32 v19, 0xffff0000, v36
    v_mul_f32 v104, v104, v18
    v_mul_f32 v105, v105, v19
    v_lshlrev_b32 v18, 16, v37
    v_and_b32 v19, 0xffff0000, v37
    v_mul_f32 v106, v106, v18
    v_mul_f32 v107, v107, v19
    v_cvt_pk_bf16_f32 v20, v107, v106
    v_cvt_pk_bf16_f32 v21, v105, v104
    v_cvt_pk_bf16_f32 v22, v103, v102
    v_cvt_pk_bf16_f32 v23, v101, v100
    v_cvt_pk_bf16_f32 v24, v99, v98
    v_cvt_pk_bf16_f32 v25, v97, v96
    v_cvt_pk_bf16_f32 v26, v95, v94
    v_cvt_pk_bf16_f32 v27, v93, v92
    v_mov_b32 v108, v20
    v_mov_b32 v109, v21
    v_mov_b32 v110, v22
    v_mov_b32 v111, v23
    v_mov_b32_dpp v20, v24 row_ror:8 row_mask:0xf bank_mask:0xc
    v_mov_b32_dpp v21, v25 row_ror:8 row_mask:0xf bank_mask:0xc
    v_mov_b32_dpp v22, v26 row_ror:8 row_mask:0xf bank_mask:0xc
    v_mov_b32_dpp v23, v27 row_ror:8 row_mask:0xf bank_mask:0xc
    v_mov_b32_dpp v24, v108 row_ror:8 row_mask:0xf bank_mask:0x3
    v_mov_b32_dpp v25, v109 row_ror:8 row_mask:0xf bank_mask:0x3
    v_mov_b32_dpp v26, v110 row_ror:8 row_mask:0xf bank_mask:0x3
    v_mov_b32_dpp v27, v111 row_ror:8 row_mask:0xf bank_mask:0x3
    buffer_store_dwordx4 v[20:23], v15, s[32:35], 0 offen sc1
    buffer_store_dwordx4 v[24:27], v15, s[32:35], s58 offen sc1
    s_waitcnt vmcnt(2)
    v_mov_b32 v32, 0
    v_mov_b32 v33, 0
    v_mov_b32 v34, 0
    v_mov_b32 v35, 0
    v_bfe_u32 v7, v1, 2, 1
    v_mul_u32_u24 v7, 16640, v7
    v_and_b32 v8, 3, v1
    v_mul_u32_u24 v9, 4160, v8
    v_add_u32 v7, v7, v9
    v_and_b32 v8, 11, v1
    v_add_u32 v9, 16, v7
    v_cmp_eq_u32 vcc, 8, v8
    s_nop 1
    v_cndmask_b32 v7, v7, v9, vcc
    ds_write_b128 v7, v[32:35]
    s_mul_i32 s52, s48, 16640
    s_add_u32 s52, s52, 16
    v_add_u32 v129, s52, v129
    ds_write_b128 v129, v[116:119] offset:16
    v_alignbit_b32 v132, v113, v112, 16
    v_alignbit_b32 v133, v114, v113, 16
    v_alignbit_b32 v134, v115, v114, 16
    v_alignbit_b32 v135, v116, v115, 16
    v_alignbit_b32 v136, v117, v116, 16
    v_pk_mov_b32 v[142:143], v[112:113], v[114:115] op_sel:[1,0]
    v_pk_mov_b32 v[144:145], v[114:115], v[116:117] op_sel:[1,0]
    ds_write_b128 v129, v[132:135] offset:4160
    v_pk_mov_b32 v[138:139], v[132:133], v[134:135] op_sel:[1,0]
    v_pk_mov_b32 v[140:141], v[134:135], v[136:137] op_sel:[1,0]
    ds_write_b128 v129, v[142:145] offset:8320
    ds_write_b128 v129, v[138:141] offset:12480
    ds_write_b128 v129, v[124:127] offset:1040
    v_alignbit_b32 v146, v121, v120, 16
    v_alignbit_b32 v147, v122, v121, 16
    v_alignbit_b32 v148, v123, v122, 16
    v_alignbit_b32 v149, v124, v123, 16
    v_alignbit_b32 v150, v125, v124, 16
    v_alignbit_b32 v151, v126, v125, 16
    v_alignbit_b32 v152, v127, v126, 16
    v_pk_mov_b32 v[160:161], v[120:121], v[122:123] op_sel:[1,0]
    v_pk_mov_b32 v[162:163], v[122:123], v[124:125] op_sel:[1,0]
    v_pk_mov_b32 v[164:165], v[124:125], v[126:127] op_sel:[1,0]
    ds_write_b128 v129, v[146:149] offset:5184
    v_pk_mov_b32 v[154:155], v[146:147], v[148:149] op_sel:[1,0]
    v_pk_mov_b32 v[156:157], v[148:149], v[150:151] op_sel:[1,0]
    v_pk_mov_b32 v[158:159], v[150:151], v[152:153] op_sel:[1,0]
    ds_write_b128 v129, v[160:163] offset:9344
    ds_write_b128 v129, v[154:157] offset:13504
    ds_write_b64 v129, v[150:151] offset:5200
    ds_write_b64 v129, v[164:165] offset:9360
    ds_write_b64 v129, v[158:159] offset:13520
    s_add_u32 s64, s12, 6496256
    s_addc_u32 s65, s13, 0
    s_cmp_lg_u32 s44, 0
    s_cbranch_scc1 a_tagdone
    v_readfirstlane_b32 s52, v130
    s_mov_b32 s53, 0
    s_cmp_lg_u32 s52, 0
    s_cbranch_scc1 a_taggot
a_tagpoll:
    global_load_dword v130, v14, s[14:15] sc1
    s_add_u32 s53, s53, 1
    s_waitcnt vmcnt(0)
    v_readfirstlane_b32 s52, v130
    s_nop 0
    s_cmp_lg_u32 s52, 0
    s_cbranch_scc1 a_taggot
    s_cmp_lt_u32 s53, 200000
    s_cbranch_scc0 a_taggot
    s_sleep 1
    s_branch a_tagpoll
a_taggot:
    v_mov_b32 v7, 58880
    v_mov_b32 v8, s52
    ds_write_b32 v7, v8
a_tagdone:
    s_waitcnt vmcnt(3)
    s_waitcnt vmcnt(0) lgkmcnt(0)
    s_barrier
    v_mov_b32 v7, 58880
    ds_read_b32 v130, v7
    s_lshl_b32 s52, s46, 8
    s_lshl_b32 s53, s45, 2
    s_add_u32 s52, s52, s53
    v_mov_b32 v8, s52
    s_waitcnt lgkmcnt(0)
    v_readfirstlane_b32 s59, v130
    s_cmp_lg_u32 s44, 0
    s_cbranch_scc1 a_nosigA
    s_mov_b64 exec, 1
    global_store_dword v8, v130, s[64:65] sc1
    s_mov_b64 exec, -1
a_nosigA:
    ds_read_b64_tr_b16 v[60:61], v12 offset:50688
    ds_read_b64_tr_b16 v[62:63], v13 offset:51200
    ds_read_b64_tr_b16 v[64:65], v12 offset:51712
    ds_read_b64_tr_b16 v[66:67], v13 offset:52224
    v_and_b32 v2, 15, v1
    v_lshrrev_b32 v3, 4, v1
    v_add_u32 v4, 1, v2
    v_and_b32 v5, 3, v4
    v_mul_u32_u24 v5, 4160, v5
    v_lshrrev_b32 v4, 2, v4
    v_lshl_add_u32 v4, v3, 1, v4
    v_lshl_add_u32 v5, v4, 3, v5
    s_mul_i32 s52, s48, 16640
    s_lshl_b32 s53, s49, 8
    s_add_u32 s52, s52, s53
    v_add_u32 v244, s52, v5
    v_lshlrev_b32 v6, 4, v3
    v_lshlrev_b32 v7, 5, v2
    v_sub_u32 v6, v6, v7
    s_mul_i32 s52, s48, 4608
    s_add_u32 s52, s52, s53
    s_add_u32 s52, s52, 33760
    v_add_u32 v245, s52, v6
    s_waitcnt lgkmcnt(0)
    v_mov_b32 v108, v60
    v_mov_b32 v109, v61
    v_mov_b32 v110, v62
    v_mov_b32 v111, v63
    v_mov_b32_dpp v60, v64 row_ror:8 row_mask:0xf bank_mask:0xc
    v_mov_b32_dpp v61, v65 row_ror:8 row_mask:0xf bank_mask:0xc
    v_mov_b32_dpp v62, v66 row_ror:8 row_mask:0xf bank_mask:0xc
    v_mov_b32_dpp v63, v67 row_ror:8 row_mask:0xf bank_mask:0xc
    v_mov_b32_dpp v64, v108 row_ror:8 row_mask:0xf bank_mask:0x3
    v_mov_b32_dpp v65, v109 row_ror:8 row_mask:0xf bank_mask:0x3
    v_mov_b32_dpp v66, v110 row_ror:8 row_mask:0xf bank_mask:0x3
    v_mov_b32_dpp v67, v111 row_ror:8 row_mask:0xf bank_mask:0x3
    buffer_store_dwordx4 v[60:63], v16, s[36:39], 0 offen sc1
    buffer_store_dwordx4 v[64:67], v16, s[36:39], s58 offen sc1
    s_lshl_b32 s52, s48, 4
    v_lshrrev_b32 v131, s52, v131
    v_and_b32 v131, 0xffff, v131
    v_lshlrev_b32 v7, 3, v3
    v_add_u32 v7, v7, v2
    v_sub_u32 v7, 15, v7
    v_and_b32 v8, 1, v7
    v_lshlrev_b32 v8, 4, v8
    v_lshlrev_b32 v8, v8, v131
    v_lshrrev_b32 v7, 1, v7
    v_cmp_eq_u32 vcc, 0, v7
    s_nop 1
    v_cndmask_b32 v192, 0, v8, vcc
    v_cmp_eq_u32 vcc, 1, v7
    s_nop 1
    v_cndmask_b32 v193, 0, v8, vcc
    v_cmp_eq_u32 vcc, 2, v7
    s_nop 1
    v_cndmask_b32 v194, 0, v8, vcc
    v_cmp_eq_u32 vcc, 3, v7
    s_nop 1
    v_cndmask_b32 v195, 0, v8, vcc
    s_waitcnt vmcnt(8)
    v_lshlrev_b32 v70, 16, v48
    v_and_b32 v71, 0xffff0000, v48
    v_lshlrev_b32 v72, 16, v49
    v_and_b32 v73, 0xffff0000, v49
    v_lshlrev_b32 v74, 16, v50
    v_and_b32 v75, 0xffff0000, v50
    v_lshlrev_b32 v76, 16, v51
    v_and_b32 v77, 0xffff0000, v51
    v_lshlrev_b32 v78, 16, v52
    v_and_b32 v79, 0xffff0000, v52
    v_lshlrev_b32 v80, 16, v53
    v_and_b32 v81, 0xffff0000, v53
    v_lshlrev_b32 v82, 16, v54
    v_and_b32 v83, 0xffff0000, v54
    v_lshlrev_b32 v84, 16, v55
    v_and_b32 v85, 0xffff0000, v55
    v_add_f32 v86, v70, v71
    v_add_f32 v86, v86, v72
    v_add_f32 v86, v86, v73
    v_add_f32 v86, v86, v74
    v_add_f32 v86, v86, v75
    v_add_f32 v86, v86, v76
    v_add_f32 v86, v86, v77
    v_add_f32 v87, v78, v79
    v_add_f32 v87, v87, v80
    v_add_f32 v87, v87, v81
    v_add_f32 v87, v87, v82
    v_add_f32 v87, v87, v83
    v_add_f32 v87, v87, v84
    v_add_f32 v87, v87, v85
    v_add_f32_dpp v86, v86, v86 quad_perm:[1,0,3,2] row_mask:0xf bank_mask:0xf
    s_nop 0
    v_add_f32_dpp v87, v87, v87 quad_perm:[1,0,3,2] row_mask:0xf bank_mask:0xf
    v_add_f32_dpp v86, v86, v86 quad_perm:[2,3,0,1] row_mask:0xf bank_mask:0xf
    s_nop 0
    v_add_f32_dpp v87, v87, v87 quad_perm:[2,3,0,1] row_mask:0xf bank_mask:0xf
    v_add_f32_dpp v86, v86, v86 row_half_mirror row_mask:0xf bank_mask:0xf
    s_nop 0
    v_add_f32_dpp v87, v87, v87 row_half_mirror row_mask:0xf bank_mask:0xf
    v_add_f32_dpp v86, v86, v86 row_mirror row_mask:0xf bank_mask:0xf
    s_nop 0
    v_add_f32_dpp v87, v87, v87 row_mirror row_mask:0xf bank_mask:0xf
    v_mov_b32 v88, v86
    v_mov_b32 v89, v87
    s_nop 0
    v_permlane16_swap_b32 v86, v88
    v_permlane16_swap_b32 v87, v89
    v_add_f32 v86, v86, v88
    v_add_f32 v87, v87, v89
    v_mov_b32 v88, v86
    v_mov_b32 v89, v87
    s_nop 0
    v_permlane32_swap_b32 v86, v88
    v_permlane32_swap_b32 v87, v89
    v_add_f32 v86, v86, v88
    v_add_f32 v87, v87, v89
    v_mul_f32 v86, 0x3b000000, v86
    v_mul_f32 v87, 0x3b000000, v87
    v_sub_f32 v70, v70, v86
    v_sub_f32 v71, v71, v86
    v_sub_f32 v72, v72, v86
    v_sub_f32 v73, v73, v86
    v_sub_f32 v74, v74, v86
    v_sub_f32 v75, v75, v86
    v_sub_f32 v76, v76, v86
    v_sub_f32 v77, v77, v86
    v_mul_f32 v90, v70, v70
    v_fmac_f32 v90, v71, v71
    v_fmac_f32 v90, v72, v72
    v_fmac_f32 v90, v73, v73
    v_fmac_f32 v90, v74, v74
    v_fmac_f32 v90, v75, v75
    v_fmac_f32 v90, v76, v76
    v_fmac_f32 v90, v77, v77
    v_sub_f32 v78, v78, v87
    v_sub_f32 v79, v79, v87
    v_sub_f32 v80, v80, v87
    v_sub_f32 v81, v81, v87
    v_sub_f32 v82, v82, v87
    v_sub_f32 v83, v83, v87
    v_sub_f32 v84, v84, v87
    v_sub_f32 v85, v85, v87
    v_mul_f32 v91, v78, v78
    v_fmac_f32 v91, v79, v79
    v_fmac_f32 v91, v80, v80
    v_fmac_f32 v91, v81, v81
    v_fmac_f32 v91, v82, v82
    v_fmac_f32 v91, v83, v83
    v_fmac_f32 v91, v84, v84
    v_fmac_f32 v91, v85, v85
    v_add_f32_dpp v90, v90, v90 quad_perm:[1,0,3,2] row_mask:0xf bank_mask:0xf
    s_nop 0
    v_add_f32_dpp v91, v91, v91 quad_perm:[1,0,3,2] row_mask:0xf bank_mask:0xf
    v_add_f32_dpp v90, v90, v90 quad_perm:[2,3,0,1] row_mask:0xf bank_mask:0xf
    s_nop 0
    v_add_f32_dpp v91, v91, v91 quad_perm:[2,3,0,1] row_mask:0xf bank_mask:0xf
    v_add_f32_dpp v90, v90, v90 row_half_mirror row_mask:0xf bank_mask:0xf
    s_nop 0
    v_add_f32_dpp v91, v91, v91 row_half_mirror row_mask:0xf bank_mask:0xf
    v_add_f32_dpp v90, v90, v90 row_mirror row_mask:0xf bank_mask:0xf
    s_nop 0
    v_add_f32_dpp v91, v91, v91 row_mirror row_mask:0xf bank_mask:0xf
    v_mov_b32 v88, v90
    v_mov_b32 v89, v91
    s_nop 0
    v_permlane16_swap_b32 v90, v88
    v_permlane16_swap_b32 v91, v89
    v_add_f32 v90, v90, v88
    v_add_f32 v91, v91, v89
    v_mov_b32 v88, v90
    v_mov_b32 v89, v91
    s_nop 0
    v_permlane32_swap_b32 v90, v88
    v_permlane32_swap_b32 v91, v89
    v_add_f32 v90, v90, v88
    v_add_f32 v91, v91, v89
    v_mov_b32 v92, 0x3727c5ac
    v_mov_b32 v93, 0x3727c5ac
    v_fmac_f32 v92, 0x3b000000, v90
    v_fmac_f32 v93, 0x3b000000, v91
    v_rsq_f32 v97, v92
    v_rsq_f32 v99, v93
    v_mov_b32 v96, v86
    v_mov_b32 v98, v87
    s_lshl_b32 s52, s51, 3
    v_mov_b32 v100, s52
    s_mov_b64 exec, 1
    buffer_store_dwordx4 v[96:99], v100, s[40:43], 0 offen sc1
    s_mov_b64 exec, -1
    s_waitcnt vmcnt(0) lgkmcnt(0)
    s_barrier
    s_cmp_lg_u32 s44, 0
    s_cbranch_scc1 a_nosigB
    s_lshl_b32 s52, s46, 7
    s_lshl_b32 s53, s45, 2
    s_add_u32 s52, s52, s53
    s_add_u32 s52, s52, 4096
    v_mov_b32 v9, s52
    v_mov_b32 v10, s59
    s_mov_b64 exec, 1
    global_store_dword v9, v10, s[64:65] sc1
    s_mov_b64 exec, -1
a_nosigB:
    s_lshl_b32 s52, s46, 8
    v_lshl_add_u32 v7, v1, 2, s52
    s_cmp_lg_u32 s44, 0
    s_cbranch_scc1 a_joinA
    s_mov_b32 s53, 0
    s_mov_b64 exec, 0xffffffff
a_pollA:
    global_load_dword v8, v7, s[64:65] sc1
    s_add_u32 s53, s53, 1
    s_waitcnt vmcnt(0)
    v_cmp_eq_u32 vcc, s59, v8
    s_nop 4
    s_cmp_eq_u32 vcc_lo, -1
    s_cbranch_scc1 a_gotA
    s_cmp_lt_u32 s53, 200000
    s_cbranch_scc0 a_gotA
    s_sleep 2
    s_branch a_pollA
a_gotA:
    s_mov_b64 exec, -1
a_joinA:
    s_barrier
    s_lshl_b32 s52, s49, 11
    s_add_u32 s53, s52, s50
    v_lshlrev_b32 v9, 4, v1
    v_add_u32 v246, s53, v9
    buffer_load_dwordx4 v[196:199], v246, s[32:35], 0 offen sc1
    buffer_load_dwordx4 v[200:203], v246, s[32:35], 0 offen offset:1024 sc1
    s_mul_i32 s53, s48, 4608
    s_add_u32 s53, s53, s52
    s_add_u32 s53, s53, 33280
    v_add_u32 v10, s53, v9
    s_lshl_b32 s53, s48, 12
    s_add_u32 s53, s53, s52
    s_add_u32 s53, s53, 42496
    v_add_u32 v247, s53, v9
    v_mov_b32 v32, 0
    v_mov_b32 v33, 0
    v_mov_b32 v34, 0
    v_mov_b32 v35, 0
    v_lshrrev_b32 v11, 5, v1
    v_mul_u32_u24 v11, 4608, v11
    v_and_b32 v12, 31, v1
    v_lshl_add_u32 v11, v12, 4, v11
    v_add_u32 v11, 37376, v11
    ds_write_b128 v11, v[32:35]
    s_waitcnt vmcnt(0)
    ds_write_b128 v10, v[196:199]
    ds_write_b128 v10, v[200:203] offset:1024
    s_waitcnt lgkmcnt(0)
    s_barrier
    ds_read_b64 v[96:97], v244 offset:0
    ds_read_b64 v[98:99], v244 offset:8
    ds_read_b128 v[128:131], v245 offset:3584
    ds_read_b64 v[100:101], v244 offset:512
    ds_read_b64 v[102:103], v244 offset:520
    ds_read_b128 v[132:135], v245 offset:3072
    ds_read_b64 v[104:105], v244 offset:1024
    ds_read_b64 v[106:107], v244 offset:1032
    ds_read_b128 v[136:139], v245 offset:2560
    ds_read_b64 v[108:109], v244 offset:1536
    ds_read_b64 v[110:111], v244 offset:1544
    ds_read_b128 v[140:143], v245 offset:2048
    s_waitcnt lgkmcnt(6)
    ds_read_b64 v[112:113], v244 offset:2048
    ds_read_b64 v[114:115], v244 offset:2056
    ds_read_b128 v[144:147], v245 offset:1536
    ds_read_b64 v[116:117], v244 offset:2560
    ds_read_b64 v[118:119], v244 offset:2568
    ds_read_b128 v[148:151], v245 offset:1024
    s_waitcnt lgkmcnt(6)
    ds_read_b64 v[120:121], v244 offset:3072
    ds_read_b64 v[122:123], v244 offset:3080
    ds_read_b128 v[152:155], v245 offset:512
    ds_read_b64 v[124:125], v244 offset:3584
    ds_read_b64 v[126:127], v244 offset:3592
    ds_read_b128 v[156:159], v245 offset:0
    s_load_dwordx4 s[20:23], s[0:1], 56
    s_load_dwordx2 s[24:25], s[0:1], 72
    v_lshlrev_b32 v14, 4, v1
    v_add_u32 v14, 4096, v14
    s_lshl_b32 s52, s44, 12
    v_lshlrev_b32 v11, 3, v1
    v_add_u32 v11, s52, v11
    s_waitcnt lgkmcnt(0)
    s_waitcnt lgkmcnt(0)
    v_mfma_f32_16x16x32_bf16 v[64:67], v[96:99], v[128:131], 0
    ds_read_b64 v[16:17], v244 offset:64
    s_lshl_b32 s52, s2, 1
    v_mfma_f32_16x16x32_bf16 v[68:71], v[96:99], v[132:135], 0
    ds_read_b64 v[18:19], v244 offset:72
    s_add_u32 s52, s52, s44
    v_mfma_f32_16x16x32_bf16 v[72:75], v[96:99], v[136:139], 0
    ds_read_b128 v[160:163], v245 offset:3648
    s_cmp_lt_u32 s44, 2
    s_cselect_b32 s72, s52, 448
    v_mfma_f32_16x16x32_bf16 v[76:79], v[96:99], v[140:143], 0
    ds_read_b64 v[20:21], v244 offset:576
    s_mov_b32 s28, s24
    v_mfma_f32_16x16x32_bf16 v[80:83], v[96:99], v[144:147], 0
    ds_read_b64 v[22:23], v244 offset:584
    s_mov_b32 s29, s25
    v_mfma_f32_16x16x32_bf16 v[84:87], v[96:99], v[148:151], 0
    ds_read_b128 v[164:167], v245 offset:3136
    s_mov_b32 s30, 1835008
    v_mfma_f32_16x16x32_bf16 v[88:91], v[96:99], v[152:155], 0
    ds_read_b64 v[24:25], v244 offset:1088
    s_mov_b32 s31, 131072
    v_mfma_f32_16x16x32_bf16 v[92:95], v[96:99], v[156:159], 0
    ds_read_b64 v[26:27], v244 offset:1096
    s_cmp_ge_u32 s72, 448
    s_cselect_b32 s30, 0, s30
    v_mfma_f32_16x16x32_bf16 v[68:71], v[100:103], v[128:131], v[68:71]
    ds_read_b128 v[168:171], v245 offset:2624
    v_bfe_u32 v249, v1, 4, 2
    v_mfma_f32_16x16x32_bf16 v[72:75], v[100:103], v[132:135], v[72:75]
    ds_read_b64 v[28:29], v244 offset:1600
    v_lshlrev_b32 v249, 1, v249
    v_mfma_f32_16x16x32_bf16 v[76:79], v[100:103], v[136:139], v[76:79]
    ds_read_b64 v[30:31], v244 offset:1608
    v_and_b32 v248, 7, v1
    v_mfma_f32_16x16x32_bf16 v[80:83], v[100:103], v[140:143], v[80:83]
    ds_read_b128 v[172:175], v245 offset:2112
    v_xor_b32 v248, v248, v249
    v_mfma_f32_16x16x32_bf16 v[84:87], v[100:103], v[144:147], v[84:87]
    ds_read_b64 v[32:33], v244 offset:2112
    v_lshlrev_b32 v248, 4, v248
    v_mfma_f32_16x16x32_bf16 v[88:91], v[100:103], v[148:151], v[88:91]
    ds_read_b64 v[34:35], v244 offset:2120
    v_lshrrev_b32 v249, 3, v1
    v_mfma_f32_16x16x32_bf16 v[92:95], v[100:103], v[152:155], v[92:95]
    ds_read_b128 v[176:179], v245 offset:1600
    v_lshl_add_u32 v248, v249, 10, v248
    v_mfma_f32_16x16x32_bf16 v[72:75], v[104:107], v[128:131], v[72:75]
    ds_read_b64 v[36:37], v244 offset:2624
    s_lshr_b32 s52, s72, 3
    v_mfma_f32_16x16x32_bf16 v[76:79], v[104:107], v[132:135], v[76:79]
    ds_read_b64 v[38:39], v244 offset:2632
    s_lshl_b32 s52, s52, 15
    v_mfma_f32_16x16x32_bf16 v[80:83], v[104:107], v[136:139], v[80:83]
    ds_read_b128 v[180:183], v245 offset:1088
    s_and_b32 s53, s72, 7
    v_mfma_f32_16x16x32_bf16 v[84:87], v[104:107], v[140:143], v[84:87]
    ds_read_b64 v[40:41], v244 offset:3136
    s_lshl_b32 s53, s53, 7
    v_mfma_f32_16x16x32_bf16 v[88:91], v[104:107], v[144:147], v[88:91]
    ds_read_b64 v[42:43], v244 offset:3144
    s_add_u32 s52, s52, s53
    v_mfma_f32_16x16x32_bf16 v[92:95], v[104:107], v[148:151], v[92:95]
    ds_read_b128 v[184:187], v245 offset:576
    v_add_u32 v248, s52, v248
    v_mfma_f32_16x16x32_bf16 v[76:79], v[108:111], v[128:131], v[76:79]
    ds_read_b64 v[44:45], v244 offset:3648
    s_lshl_b32 s74, s44, 12
    v_mfma_f32_16x16x32_bf16 v[80:83], v[108:111], v[132:135], v[80:83]
    ds_read_b64 v[46:47], v244 offset:3656
    s_add_u32 s74, s74, 58896
    v_mfma_f32_16x16x32_bf16 v[84:87], v[108:111], v[136:139], v[84:87]
    ds_read_b128 v[188:191], v245 offset:64
    s_mov_b32 s68, s20
    v_mfma_f32_16x16x32_bf16 v[88:91], v[108:111], v[140:143], v[88:91]
    s_mov_b32 s69, s21
    s_mov_b32 s70, 1835008
    v_mfma_f32_16x16x32_bf16 v[92:95], v[108:111], v[144:147], v[92:95]
    s_mov_b32 s71, 131072
    s_mov_b32 s60, s22
    v_mfma_f32_16x16x32_bf16 v[80:83], v[112:115], v[128:131], v[80:83]
    s_mov_b32 s61, s23
    s_mov_b32 s62, 1835008
    v_mfma_f32_16x16x32_bf16 v[84:87], v[112:115], v[132:135], v[84:87]
    s_mov_b32 s63, 131072
    s_mul_i32 s52, s2, 7168
    v_mfma_f32_16x16x32_bf16 v[88:91], v[112:115], v[136:139], v[88:91]
    s_mul_i32 s53, s44, 1792
    s_add_u32 s52, s52, s53
    v_mfma_f32_16x16x32_bf16 v[92:95], v[112:115], v[140:143], v[92:95]
    v_lshl_add_u32 v249, v1, 4, s52
    s_mov_b32 s21, 65536
    v_mfma_f32_16x16x32_bf16 v[84:87], v[116:119], v[128:131], v[84:87]
    s_mov_b32 s22, 131072
    s_mov_b32 s23, 196608
    v_mfma_f32_16x16x32_bf16 v[88:91], v[116:119], v[132:135], v[88:91]
    s_mov_b32 s24, 262144
    s_mov_b32 s25, 327680
    v_mfma_f32_16x16x32_bf16 v[92:95], v[116:119], v[136:139], v[92:95]
    s_mov_b32 s26, 393216
    s_mov_b32 s27, 458752
    v_mfma_f32_16x16x32_bf16 v[88:91], v[120:123], v[128:131], v[88:91]
    s_add_u32 m0, s74, 0
    s_mov_b32 s52, 0
    buffer_load_dwordx4 v248, s[28:31], s52 offen lds
    s_add_u32 m0, s74, 1024
    s_mov_b32 s52, 8192
    buffer_load_dwordx4 v248, s[28:31], s52 offen lds
    v_mfma_f32_16x16x32_bf16 v[92:95], v[120:123], v[132:135], v[92:95]
    s_add_u32 m0, s74, 2048
    s_mov_b32 s52, 16384
    buffer_load_dwordx4 v248, s[28:31], s52 offen lds
    s_add_u32 m0, s74, 3072
    s_mov_b32 s52, 24576
    buffer_load_dwordx4 v248, s[28:31], s52 offen lds
    v_mfma_f32_16x16x32_bf16 v[92:95], v[124:127], v[128:131], v[92:95]
    v_and_b32 v2, 15, v1
    v_lshrrev_b32 v3, 4, v1
    s_cmp_lg_u32 s49, 0
    s_cbranch_scc1 a_noskip
    v_mfma_f32_16x16x32_bf16 v[64:67], v[192:195], v[128:131], v[64:67]
    v_mfma_f32_16x16x32_bf16 v[68:71], v[192:195], v[132:135], v[68:71]
    v_mfma_f32_16x16x32_bf16 v[72:75], v[192:195], v[136:139], v[72:75]
    v_mfma_f32_16x16x32_bf16 v[76:79], v[192:195], v[140:143], v[76:79]
    v_mfma_f32_16x16x32_bf16 v[80:83], v[192:195], v[144:147], v[80:83]
    v_mfma_f32_16x16x32_bf16 v[84:87], v[192:195], v[148:151], v[84:87]
    v_mfma_f32_16x16x32_bf16 v[88:91], v[192:195], v[152:155], v[88:91]
    v_mfma_f32_16x16x32_bf16 v[92:95], v[192:195], v[156:159], v[92:95]
a_noskip:
    s_waitcnt lgkmcnt(0)
    v_mfma_f32_16x16x32_bf16 v[64:67], v[16:19], v[160:163], v[64:67]
    ds_read_b64 v[96:97], v244 offset:128
    v_mul_u32_u24 v3, 288, v3
    v_mfma_f32_16x16x32_bf16 v[68:71], v[16:19], v[164:167], v[68:71]
    ds_read_b64 v[98:99], v244 offset:136
    v_lshl_add_u32 v3, v2, 4, v3
    v_mfma_f32_16x16x32_bf16 v[72:75], v[16:19], v[168:171], v[72:75]
    ds_read_b128 v[128:131], v245 offset:3712
    s_mul_i32 s52, s44, 9216
    v_mfma_f32_16x16x32_bf16 v[76:79], v[16:19], v[172:175], v[76:79]
    ds_read_b64 v[100:101], v244 offset:640
    s_add_u32 s52, s52, 75280
    v_mfma_f32_16x16x32_bf16 v[80:83], v[16:19], v[176:179], v[80:83]
    ds_read_b64 v[102:103], v244 offset:648
    v_add_u32 v3, s52, v3
    v_mfma_f32_16x16x32_bf16 v[84:87], v[16:19], v[180:183], v[84:87]
    ds_read_b128 v[132:135], v245 offset:3200
    v_lshrrev_b32 v4, 4, v1
    v_mfma_f32_16x16x32_bf16 v[88:91], v[16:19], v[184:187], v[88:91]
    ds_read_b64 v[104:105], v244 offset:1152
    v_lshlrev_b32 v4, 4, v4
    v_mfma_f32_16x16x32_bf16 v[92:95], v[16:19], v[188:191], v[92:95]
    ds_read_b64 v[106:107], v244 offset:1160
    v_bfe_u32 v5, v1, 2, 2
    v_mfma_f32_16x16x32_bf16 v[68:71], v[20:23], v[160:163], v[68:71]
    ds_read_b128 v[136:139], v245 offset:2688
    v_mul_u32_u24 v5, 288, v5
    v_mfma_f32_16x16x32_bf16 v[72:75], v[20:23], v[164:167], v[72:75]
    ds_read_b64 v[108:109], v244 offset:1664
    v_add_u32 v4, v4, v5
    v_mfma_f32_16x16x32_bf16 v[76:79], v[20:23], v[168:171], v[76:79]
    ds_read_b64 v[110:111], v244 offset:1672
    v_and_b32 v5, 3, v1
    v_mfma_f32_16x16x32_bf16 v[80:83], v[20:23], v[172:175], v[80:83]
    ds_read_b128 v[140:143], v245 offset:2176
    v_lshl_add_u32 v4, v5, 2, v4
    v_mfma_f32_16x16x32_bf16 v[84:87], v[20:23], v[176:179], v[84:87]
    ds_read_b64 v[112:113], v244 offset:2176
    s_mul_i32 s52, s44, 2304
    v_mfma_f32_16x16x32_bf16 v[88:91], v[20:23], v[180:183], v[88:91]
    ds_read_b64 v[114:115], v244 offset:2184
    s_add_u32 s52, s52, 75280
    v_mfma_f32_16x16x32_bf16 v[92:95], v[20:23], v[184:187], v[92:95]
    ds_read_b128 v[144:147], v245 offset:1664
    v_add_u32 v4, s52, v4
    v_mfma_f32_16x16x32_bf16 v[72:75], v[24:27], v[160:163], v[72:75]
    ds_read_b64 v[116:117], v244 offset:2688
    s_add_u32 s16, s12, 4194304
    s_addc_u32 s17, s13, 0
    v_mfma_f32_16x16x32_bf16 v[76:79], v[24:27], v[164:167], v[76:79]
    ds_read_b64 v[118:119], v244 offset:2696
    s_mov_b32 s18, 2097152
    v_mfma_f32_16x16x32_bf16 v[80:83], v[24:27], v[168:171], v[80:83]
    ds_read_b128 v[148:151], v245 offset:1152
    s_mov_b32 s19, 131072
    v_mfma_f32_16x16x32_bf16 v[84:87], v[24:27], v[172:175], v[84:87]
    ds_read_b64 v[120:121], v244 offset:3200
    v_lshrrev_b32 v7, 4, v1
    v_mfma_f32_16x16x32_bf16 v[88:91], v[24:27], v[176:179], v[88:91]
    ds_read_b64 v[122:123], v244 offset:3208
    v_lshlrev_b32 v7, 14, v7
    v_mfma_f32_16x16x32_bf16 v[92:95], v[24:27], v[180:183], v[92:95]
    ds_read_b128 v[152:155], v245 offset:640
    v_and_b32 v8, 15, v1
    v_mfma_f32_16x16x32_bf16 v[76:79], v[28:31], v[160:163], v[76:79]
    ds_read_b64 v[124:125], v244 offset:3712
    v_lshl_add_u32 v7, v8, 4, v7
    v_mfma_f32_16x16x32_bf16 v[80:83], v[28:31], v[164:167], v[80:83]
    ds_read_b64 v[126:127], v244 offset:3720
    s_lshl_b32 s52, s44, 19
    v_mfma_f32_16x16x32_bf16 v[84:87], v[28:31], v[168:171], v[84:87]
    ds_read_b128 v[156:159], v245 offset:128
    s_lshr_b32 s53, s47, 4
    v_mfma_f32_16x16x32_bf16 v[88:91], v[28:31], v[172:175], v[88:91]
    s_lshl_b32 s53, s53, 10
    s_add_u32 s52, s52, s53
    v_mfma_f32_16x16x32_bf16 v[92:95], v[28:31], v[176:179], v[92:95]
    s_bfe_u32 s53, s47, 0x20001
    s_lshl_b32 s53, s53, 8
    v_mfma_f32_16x16x32_bf16 v[80:83], v[32:35], v[160:163], v[80:83]
    s_add_u32 s52, s52, s53
    s_bfe_u32 s53, s47, 0x10003
    v_mfma_f32_16x16x32_bf16 v[84:87], v[32:35], v[164:167], v[84:87]
    s_lshl_b32 s53, s53, 3
    s_add_u32 s52, s52, s53
    v_mfma_f32_16x16x32_bf16 v[88:91], v[32:35], v[168:171], v[88:91]
    s_and_b32 s53, s47, 1
    s_lshl_b32 s53, s53, 2
    v_mfma_f32_16x16x32_bf16 v[92:95], v[32:35], v[172:175], v[92:95]
    s_add_u32 s52, s52, s53
    v_add_u32 v7, s52, v7
    v_mfma_f32_16x16x32_bf16 v[84:87], v[36:39], v[160:163], v[84:87]
    s_lshl_b32 s52, s44, 10
    s_add_u32 s52, s52, 42496
    v_mfma_f32_16x16x32_bf16 v[88:91], v[36:39], v[164:167], v[88:91]
    v_lshl_add_u32 v10, v1, 1, s52
    v_mov_b32 v196, 0
    v_mfma_f32_16x16x32_bf16 v[92:95], v[36:39], v[168:171], v[92:95]
    v_mov_b32 v197, 0
    v_mov_b32 v198, 0
    v_mfma_f32_16x16x32_bf16 v[88:91], v[40:43], v[160:163], v[88:91]
    v_mov_b32 v199, 0
    v_mov_b32 v200, 0
    v_mfma_f32_16x16x32_bf16 v[92:95], v[40:43], v[164:167], v[92:95]
    v_mov_b32 v201, 0
    v_mov_b32 v202, 0
    v_mfma_f32_16x16x32_bf16 v[92:95], v[44:47], v[160:163], v[92:95]
    v_mov_b32 v203, 0
    v_mov_b32 v204, 0
    global_load_dwordx4 v[232:235], v14, s[64:65] sc1
    s_waitcnt lgkmcnt(0)
    v_mfma_f32_16x16x32_bf16 v[64:67], v[96:99], v[128:131], v[64:67]
    ds_read_b64 v[16:17], v244 offset:192
    v_mov_b32 v205, 0
    v_mfma_f32_16x16x32_bf16 v[68:71], v[96:99], v[132:135], v[68:71]
    ds_read_b64 v[18:19], v244 offset:200
    v_mov_b32 v206, 0
    v_mfma_f32_16x16x32_bf16 v[72:75], v[96:99], v[136:139], v[72:75]
    ds_read_b128 v[160:163], v245 offset:3776
    v_mov_b32 v207, 0
    v_mfma_f32_16x16x32_bf16 v[76:79], v[96:99], v[140:143], v[76:79]
    ds_read_b64 v[20:21], v244 offset:704
    v_mov_b32 v208, 0
    v_mfma_f32_16x16x32_bf16 v[80:83], v[96:99], v[144:147], v[80:83]
    ds_read_b64 v[22:23], v244 offset:712
    v_mov_b32 v209, 0
    v_mfma_f32_16x16x32_bf16 v[84:87], v[96:99], v[148:151], v[84:87]
    ds_read_b128 v[164:167], v245 offset:3264
    v_mov_b32 v210, 0
    v_mfma_f32_16x16x32_bf16 v[88:91], v[96:99], v[152:155], v[88:91]
    ds_read_b64 v[24:25], v244 offset:1216
    v_mov_b32 v211, 0
    v_mfma_f32_16x16x32_bf16 v[92:95], v[96:99], v[156:159], v[92:95]
    ds_read_b64 v[26:27], v244 offset:1224
    v_mfma_f32_16x16x32_bf16 v[68:71], v[100:103], v[128:131], v[68:71]
    ds_read_b128 v[168:171], v245 offset:2752
    v_mfma_f32_16x16x32_bf16 v[72:75], v[100:103], v[132:135], v[72:75]
    ds_read_b64 v[28:29], v244 offset:1728
    v_mfma_f32_16x16x32_bf16 v[76:79], v[100:103], v[136:139], v[76:79]
    ds_read_b64 v[30:31], v244 offset:1736
    v_mfma_f32_16x16x32_bf16 v[80:83], v[100:103], v[140:143], v[80:83]
    ds_read_b128 v[172:175], v245 offset:2240
    v_mfma_f32_16x16x32_bf16 v[84:87], v[100:103], v[144:147], v[84:87]
    ds_read_b64 v[32:33], v244 offset:2240
    v_mfma_f32_16x16x32_bf16 v[88:91], v[100:103], v[148:151], v[88:91]
    ds_read_b64 v[34:35], v244 offset:2248
    v_mfma_f32_16x16x32_bf16 v[92:95], v[100:103], v[152:155], v[92:95]
    ds_read_b128 v[176:179], v245 offset:1728
    v_mfma_f32_16x16x32_bf16 v[72:75], v[104:107], v[128:131], v[72:75]
    ds_read_b64 v[36:37], v244 offset:2752
    v_mfma_f32_16x16x32_bf16 v[76:79], v[104:107], v[132:135], v[76:79]
    ds_read_b64 v[38:39], v244 offset:2760
    v_mfma_f32_16x16x32_bf16 v[80:83], v[104:107], v[136:139], v[80:83]
    ds_read_b128 v[180:183], v245 offset:1216
    v_mfma_f32_16x16x32_bf16 v[84:87], v[104:107], v[140:143], v[84:87]
    ds_read_b64 v[40:41], v244 offset:3264
    v_mfma_f32_16x16x32_bf16 v[88:91], v[104:107], v[144:147], v[88:91]
    ds_read_b64 v[42:43], v244 offset:3272
    v_mfma_f32_16x16x32_bf16 v[92:95], v[104:107], v[148:151], v[92:95]
    ds_read_b128 v[184:187], v245 offset:704
    v_mfma_f32_16x16x32_bf16 v[76:79], v[108:111], v[128:131], v[76:79]
    ds_read_b64 v[44:45], v244 offset:3776
    v_mfma_f32_16x16x32_bf16 v[80:83], v[108:111], v[132:135], v[80:83]
    ds_read_b64 v[46:47], v244 offset:3784
    v_mfma_f32_16x16x32_bf16 v[84:87], v[108:111], v[136:139], v[84:87]
    ds_read_b128 v[188:191], v245 offset:192
    v_mfma_f32_16x16x32_bf16 v[88:91], v[108:111], v[140:143], v[88:91]
    v_mfma_f32_16x16x32_bf16 v[92:95], v[108:111], v[144:147], v[92:95]
    v_mfma_f32_16x16x32_bf16 v[80:83], v[112:115], v[128:131], v[80:83]
    v_mfma_f32_16x16x32_bf16 v[84:87], v[112:115], v[132:135], v[84:87]
    v_mfma_f32_16x16x32_bf16 v[88:91], v[112:115], v[136:139], v[88:91]
    v_mfma_f32_16x16x32_bf16 v[92:95], v[112:115], v[140:143], v[92:95]
    v_mfma_f32_16x16x32_bf16 v[84:87], v[116:119], v[128:131], v[84:87]
    v_mfma_f32_16x16x32_bf16 v[88:91], v[116:119], v[132:135], v[88:91]
    v_mfma_f32_16x16x32_bf16 v[92:95], v[116:119], v[136:139], v[92:95]
    v_mfma_f32_16x16x32_bf16 v[88:91], v[120:123], v[128:131], v[88:91]
    v_mfma_f32_16x16x32_bf16 v[92:95], v[120:123], v[132:135], v[92:95]
    v_mfma_f32_16x16x32_bf16 v[92:95], v[124:127], v[128:131], v[92:95]
    s_waitcnt vmcnt(0)
    s_mov_b32 s73, 0
    v_cmp_eq_u32 s[52:53], s59, v232
    v_cmp_eq_u32 s[54:55], s59, v233
    v_cmp_eq_u32 s[56:57], s59, v234
    v_cmp_eq_u32 vcc, s59, v235
    s_nop 3
    s_and_b64 s[52:53], s[52:53], s[54:55]
    s_and_b64 s[56:57], s[56:57], vcc
    s_and_b64 s[52:53], s[52:53], s[56:57]
    s_cmp_eq_u64 s[52:53], -1
    s_cselect_b32 s73, 1, 0
    s_cselect_b32 s38, 2097152, 0
    s_cselect_b32 s42, 16384, 0
    s_waitcnt lgkmcnt(0)
    v_mfma_f32_16x16x32_bf16 v[64:67], v[16:19], v[160:163], v[64:67]
    buffer_load_dwordx4 v[236:239], v246, s[36:39], 0 offen sc1
    v_bfe_u32 v116, v1, 2, 2
    v_lshrrev_b32 v117, 4, v1
    v_mfma_f32_16x16x32_bf16 v[68:71], v[16:19], v[164:167], v[68:71]
    v_lshl_add_u32 v116, v117, 2, v116
    v_bfe_u32 v117, v116, 1, 2
    v_mfma_f32_16x16x32_bf16 v[72:75], v[16:19], v[168:171], v[72:75]
    buffer_load_dwordx4 v[240:243], v246, s[36:39], 0 offen offset:1024 sc1
    v_lshlrev_b32 v117, 1, v117
    v_lshlrev_b32 v116, 7, v116
    v_mfma_f32_16x16x32_bf16 v[76:79], v[16:19], v[172:175], v[76:79]
    v_and_b32 v118, 1, v1
    v_lshl_add_u32 v116, v118, 3, v116
    v_mfma_f32_16x16x32_bf16 v[80:83], v[16:19], v[176:179], v[80:83]
    buffer_load_dwordx2 v[216:217], v11, s[40:43], 0 offen offset:0 sc1
    v_bfe_u32 v118, v1, 1, 1
    v_xor_b32 v117, v117, v118
    v_mfma_f32_16x16x32_bf16 v[84:87], v[16:19], v[180:183], v[84:87]
    v_xor_b32 v96, 0, v117
    v_lshl_add_u32 v96, v96, 4, v116
    v_mfma_f32_16x16x32_bf16 v[88:91], v[16:19], v[184:187], v[88:91]
    buffer_load_dwordx2 v[218:219], v11, s[40:43], 0 offen offset:512 sc1
    v_xor_b32 v97, 2, v117
    v_lshl_add_u32 v97, v97, 4, v116
    v_mfma_f32_16x16x32_bf16 v[92:95], v[16:19], v[188:191], v[92:95]
    v_xor_b32 v98, 4, v117
    v_lshl_add_u32 v98, v98, 4, v116
    v_mfma_f32_16x16x32_bf16 v[68:71], v[20:23], v[160:163], v[68:71]
    buffer_load_dwordx2 v[220:221], v11, s[40:43], 0 offen offset:1024 sc1
    v_xor_b32 v99, 6, v117
    v_lshl_add_u32 v99, v99, 4, v116
    v_mfma_f32_16x16x32_bf16 v[72:75], v[20:23], v[164:167], v[72:75]
    v_add_u32 v96, s74, v96
    v_add_u32 v97, s74, v97
    v_mfma_f32_16x16x32_bf16 v[76:79], v[20:23], v[168:171], v[76:79]
    buffer_load_dwordx2 v[222:223], v11, s[40:43], 0 offen offset:1536 sc1
    v_add_u32 v98, s74, v98
    v_add_u32 v99, s74, v99
    v_mfma_f32_16x16x32_bf16 v[80:83], v[20:23], v[172:175], v[80:83]
    ds_read_b64_tr_b16 v[100:101], v96 offset:0
    ds_read_b64_tr_b16 v[102:103], v96 offset:2048
    v_mfma_f32_16x16x32_bf16 v[84:87], v[20:23], v[176:179], v[84:87]
    buffer_load_dwordx2 v[224:225], v11, s[40:43], 0 offen offset:2048 sc1
    ds_read_b64_tr_b16 v[104:105], v97 offset:0
    ds_read_b64_tr_b16 v[106:107], v97 offset:2048
    v_mfma_f32_16x16x32_bf16 v[88:91], v[20:23], v[180:183], v[88:91]
    ds_read_b64_tr_b16 v[108:109], v98 offset:0
    ds_read_b64_tr_b16 v[110:111], v98 offset:2048
    v_mfma_f32_16x16x32_bf16 v[92:95], v[20:23], v[184:187], v[92:95]
    buffer_load_dwordx2 v[226:227], v11, s[40:43], 0 offen offset:2560 sc1
    ds_read_b64_tr_b16 v[112:113], v99 offset:0
    ds_read_b64_tr_b16 v[114:115], v99 offset:2048
    v_mfma_f32_16x16x32_bf16 v[72:75], v[24:27], v[160:163], v[72:75]
    s_add_u32 s28, s12, 12582912
    s_addc_u32 s29, s13, 0
    s_mov_b32 s30, 1835008
    v_mfma_f32_16x16x32_bf16 v[76:79], v[24:27], v[164:167], v[76:79]
    buffer_load_dwordx2 v[228:229], v11, s[40:43], 0 offen offset:3072 sc1
    s_mov_b32 s31, 131072
    s_cmp_ge_u32 s72, 448
    s_cselect_b32 s30, 0, s30
    v_mfma_f32_16x16x32_bf16 v[80:83], v[24:27], v[168:171], v[80:83]
    s_and_b32 s52, s72, 7
    s_mul_i32 s52, s52, 56
    v_mfma_f32_16x16x32_bf16 v[84:87], v[24:27], v[172:175], v[84:87]
    buffer_load_dwordx2 v[230:231], v11, s[40:43], 0 offen offset:3584 sc1
    s_lshr_b32 s53, s72, 3
    s_add_u32 s52, s52, s53
    v_mfma_f32_16x16x32_bf16 v[88:91], v[24:27], v[176:179], v[88:91]
    s_lshl_b32 s52, s52, 12
    v_lshl_add_u32 v119, v1, 4, s52
    v_mfma_f32_16x16x32_bf16 v[92:95], v[24:27], v[180:183], v[92:95]
    buffer_load_dwordx4 v[212:215], v249, s[68:71], 0 offen offset:0
    s_waitcnt lgkmcnt(0)
    v_mfma_f32_16x16x32_bf16 v[76:79], v[28:31], v[160:163], v[76:79]
    v_mfma_f32_16x16x32_bf16 v[80:83], v[28:31], v[164:167], v[80:83]
    buffer_load_dwordx4 v[212:215], v249, s[68:71], 0 offen offset:768
    v_mfma_f32_16x16x32_bf16 v[84:87], v[28:31], v[168:171], v[84:87]
    v_mfma_f32_16x16x32_bf16 v[88:91], v[28:31], v[172:175], v[88:91]
    buffer_load_dwordx4 v[212:215], v249, s[60:63], 0 offen offset:0
    v_mfma_f32_16x16x32_bf16 v[92:95], v[28:31], v[176:179], v[92:95]
    v_mfma_f32_16x16x32_bf16 v[80:83], v[32:35], v[160:163], v[80:83]
    buffer_load_dwordx4 v[212:215], v249, s[60:63], 0 offen offset:768
    buffer_store_dwordx4 v[100:103], v119, s[28:31], 0 offen offset:0 sc1
    v_mfma_f32_16x16x32_bf16 v[84:87], v[32:35], v[164:167], v[84:87]
    buffer_store_dwordx4 v[104:107], v119, s[28:31], 0 offen offset:1024 sc1
    v_mfma_f32_16x16x32_bf16 v[88:91], v[32:35], v[168:171], v[88:91]
    buffer_store_dwordx4 v[108:111], v119, s[28:31], 0 offen offset:2048 sc1
    v_mfma_f32_16x16x32_bf16 v[92:95], v[32:35], v[172:175], v[92:95]
    buffer_store_dwordx4 v[112:115], v119, s[28:31], 0 offen offset:3072 sc1
    v_mfma_f32_16x16x32_bf16 v[84:87], v[36:39], v[160:163], v[84:87]
    v_mfma_f32_16x16x32_bf16 v[88:91], v[36:39], v[164:167], v[88:91]
    v_mfma_f32_16x16x32_bf16 v[92:95], v[36:39], v[168:171], v[92:95]
    v_mfma_f32_16x16x32_bf16 v[88:91], v[40:43], v[160:163], v[88:91]
    v_mfma_f32_16x16x32_bf16 v[92:95], v[40:43], v[164:167], v[92:95]
    v_mfma_f32_16x16x32_bf16 v[92:95], v[44:47], v[160:163], v[92:95]
    s_cmp_eq_u32 s73, 1
    s_cbranch_scc1 a_haveX
    s_mov_b32 s58, 0
a_chkB:
    global_load_dwordx4 v[232:235], v14, s[64:65] sc1
    s_add_u32 s58, s58, 1
    s_waitcnt vmcnt(0)
    v_cmp_eq_u32 s[52:53], s59, v232
    v_cmp_eq_u32 s[54:55], s59, v233
    v_cmp_eq_u32 s[56:57], s59, v234
    v_cmp_eq_u32 vcc, s59, v235
    s_nop 3
    s_and_b64 s[52:53], s[52:53], s[54:55]
    s_and_b64 s[56:57], s[56:57], vcc
    s_and_b64 s[52:53], s[52:53], s[56:57]
    s_cmp_eq_u64 s[52:53], -1
    s_cbranch_scc1 a_gotB
    s_cmp_lt_u32 s58, 200000
    s_cbranch_scc0 a_gotB
    s_sleep 4
    s_branch a_chkB
a_gotB:
    s_mov_b32 s38, 2097152
    s_mov_b32 s42, 16384
    buffer_load_dwordx4 v[236:239], v246, s[36:39], 0 offen sc1
    buffer_load_dwordx4 v[240:243], v246, s[36:39], 0 offen offset:1024 sc1
    buffer_load_dwordx2 v[216:217], v11, s[40:43], 0 offen offset:0 sc1
    buffer_load_dwordx2 v[218:219], v11, s[40:43], 0 offen offset:512 sc1
    buffer_load_dwordx2 v[220:221], v11, s[40:43], 0 offen offset:1024 sc1
    buffer_load_dwordx2 v[222:223], v11, s[40:43], 0 offen offset:1536 sc1
    buffer_load_dwordx2 v[224:225], v11, s[40:43], 0 offen offset:2048 sc1
    buffer_load_dwordx2 v[226:227], v11, s[40:43], 0 offen offset:2560 sc1
    buffer_load_dwordx2 v[228:229], v11, s[40:43], 0 offen offset:3072 sc1
    buffer_load_dwordx2 v[230:231], v11, s[40:43], 0 offen offset:3584 sc1
    s_waitcnt vmcnt(0)
a_haveX:
    ds_write_b128 v3, v[64:67] offset:0
    ds_write_b128 v3, v[68:71] offset:1152
    ds_write_b128 v3, v[72:75] offset:2304
    ds_write_b128 v3, v[76:79] offset:3456
    ds_write_b128 v3, v[80:83] offset:4608
    ds_write_b128 v3, v[84:87] offset:5760
    ds_write_b128 v3, v[88:91] offset:6912
    ds_write_b128 v3, v[92:95] offset:8064
    s_waitcnt vmcnt(16)
    ds_write_b128 v247, v[236:239]
    ds_write_b128 v247, v[240:243] offset:1024
    s_waitcnt lgkmcnt(0)
    s_barrier
    ds_read_b32 v96, v4 offset:0
    ds_read_b32 v97, v4 offset:9216
    ds_read_b32 v98, v4 offset:18432
    ds_read_b32 v99, v4 offset:27648
    ds_read_u16_d16_hi v196, v10 offset:0
    ds_read_u16_d16_hi v197, v10 offset:4096
    ds_read_b32 v100, v4 offset:64
    ds_read_b32 v101, v4 offset:9280
    ds_read_b32 v102, v4 offset:18496
    ds_read_b32 v103, v4 offset:27712
    ds_read_u16_d16_hi v198, v10 offset:128
    ds_read_u16_d16_hi v199, v10 offset:4224
    s_waitcnt vmcnt(8)
    s_cmp_ge_u32 s45, 3
    s_cbranch_scc1 a_notouch
    s_cmp_lg_u32 s44, 3
    s_cbranch_scc1 a_notouch
    s_load_dwordx2 s[28:29], s[0:1], 80
    s_mov_b32 s30, 0x200000
    s_mov_b32 s31, 131072
    s_mov_b32 s52, 0
    s_waitcnt lgkmcnt(0)
    s_cmp_eq_u32 s45, 2
    s_cbranch_scc1 a_touch
    s_mov_b32 s28, s12
    s_mov_b32 s29, s13
    s_mov_b32 s30, 24117248
    s_mov_b32 s52, 16777216
    s_cmp_eq_u32 s45, 1
    s_cselect_b32 s52, 20971520, s52
a_touch:
    v_lshlrev_b32 v253, 16, v1
    v_add_u32 v253, s52, v253
    buffer_load_dword v252, v253, s[28:31], 0 offen
a_notouch:
    s_getpc_b64 s[52:53]
a_kernel_pf1:
    s_add_u32 s52, s52, g_kernel-a_kernel_pf1
    s_addc_u32 s53, s53, 0
    s_lshr_b32 s54, s2, 3
    s_min_u32 s54, s54, ((code_end-g_kernel)>>10)-1
    s_lshl_b32 s54, s54, 10
    v_lshl_add_u32 v253, v1, 4, s54
    global_load_dwordx4 v[248:251], v253, s[52:53]
    s_waitcnt lgkmcnt(6)
    ds_read_b32 v104, v4 offset:128
    ds_read_b32 v105, v4 offset:9344
    ds_read_b32 v106, v4 offset:18560
    ds_read_b32 v107, v4 offset:27776
    ds_read_u16_d16_hi v200, v10 offset:256
    ds_read_u16_d16_hi v201, v10 offset:4352
    v_add_f32 v96, v96, v97
    v_add_f32 v98, v98, v99
    v_sub_f32 v132, v196, v216
    v_sub_f32 v133, v197, v216
    v_mul_f32 v132, v132, v217
    v_mul_f32 v133, v133, v217
    v_fmac_f32 v196, v132, v96
    v_fmac_f32 v197, v133, v98
    v_cvt_pk_bf16_f32 v140, v196, v197
    buffer_store_dword v140, v7, s[16:19], 0 offen
    s_waitcnt lgkmcnt(6)
    ds_read_b32 v108, v4 offset:192
    ds_read_b32 v109, v4 offset:9408
    ds_read_b32 v110, v4 offset:18624
    ds_read_b32 v111, v4 offset:27840
    ds_read_u16_d16_hi v202, v10 offset:384
    ds_read_u16_d16_hi v203, v10 offset:4480
    v_add_f32 v100, v100, v101
    v_add_f32 v102, v102, v103
    v_sub_f32 v132, v198, v218
    v_sub_f32 v133, v199, v218
    v_mul_f32 v132, v132, v219
    v_mul_f32 v133, v133, v219
    v_fmac_f32 v198, v132, v100
    v_fmac_f32 v199, v133, v102
    v_cvt_pk_bf16_f32 v141, v198, v199
    buffer_store_dword v141, v7, s[16:19], s21 offen
    s_waitcnt lgkmcnt(6)
    ds_read_b32 v112, v4 offset:1152
    ds_read_b32 v113, v4 offset:10368
    ds_read_b32 v114, v4 offset:19584
    ds_read_b32 v115, v4 offset:28800
    ds_read_u16_d16_hi v204, v10 offset:512
    ds_read_u16_d16_hi v205, v10 offset:4608
    v_add_f32 v104, v104, v105
    v_add_f32 v106, v106, v107
    v_sub_f32 v132, v200, v220
    v_sub_f32 v133, v201, v220
    v_mul_f32 v132, v132, v221
    v_mul_f32 v133, v133, v221
    v_fmac_f32 v200, v132, v104
    v_fmac_f32 v201, v133, v106
    v_cvt_pk_bf16_f32 v142, v200, v201
    buffer_store_dword v142, v7, s[16:19], s22 offen
    s_waitcnt lgkmcnt(6)
    ds_read_b32 v116, v4 offset:1216
    ds_read_b32 v117, v4 offset:10432
    ds_read_b32 v118, v4 offset:19648
    ds_read_b32 v119, v4 offset:28864
    ds_read_u16_d16_hi v206, v10 offset:640
    ds_read_u16_d16_hi v207, v10 offset:4736
    v_add_f32 v108, v108, v109
    v_add_f32 v110, v110, v111
    v_sub_f32 v132, v202, v222
    v_sub_f32 v133, v203, v222
    v_mul_f32 v132, v132, v223
    v_mul_f32 v133, v133, v223
    v_fmac_f32 v202, v132, v108
    v_fmac_f32 v203, v133, v110
    v_cvt_pk_bf16_f32 v143, v202, v203
    buffer_store_dword v143, v7, s[16:19], s23 offen
    s_waitcnt lgkmcnt(6)
    ds_read_b32 v120, v4 offset:1280
    ds_read_b32 v121, v4 offset:10496
    ds_read_b32 v122, v4 offset:19712
    ds_read_b32 v123, v4 offset:28928
    ds_read_u16_d16_hi v208, v10 offset:768
    ds_read_u16_d16_hi v209, v10 offset:4864
    v_add_f32 v112, v112, v113
    v_add_f32 v114, v114, v115
    v_sub_f32 v132, v204, v224
    v_sub_f32 v133, v205, v224
    v_mul_f32 v132, v132, v225
    v_mul_f32 v133, v133, v225
    v_fmac_f32 v204, v132, v112
    v_fmac_f32 v205, v133, v114
    v_cvt_pk_bf16_f32 v144, v204, v205
    buffer_store_dword v144, v7, s[16:19], s24 offen
    s_waitcnt lgkmcnt(6)
    ds_read_b32 v124, v4 offset:1344
    ds_read_b32 v125, v4 offset:10560
    ds_read_b32 v126, v4 offset:19776
    ds_read_b32 v127, v4 offset:28992
    ds_read_u16_d16_hi v210, v10 offset:896
    ds_read_u16_d16_hi v211, v10 offset:4992
    v_add_f32 v116, v116, v117
    v_add_f32 v118, v118, v119
    v_sub_f32 v132, v206, v226
    v_sub_f32 v133, v207, v226
    v_mul_f32 v132, v132, v227
    v_mul_f32 v133, v133, v227
    v_fmac_f32 v206, v132, v116
    v_fmac_f32 v207, v133, v118
    v_cvt_pk_bf16_f32 v145, v206, v207
    buffer_store_dword v145, v7, s[16:19], s25 offen
    s_waitcnt lgkmcnt(6)
    v_add_f32 v120, v120, v121
    v_add_f32 v122, v122, v123
    v_sub_f32 v132, v208, v228
    v_sub_f32 v133, v209, v228
    v_mul_f32 v132, v132, v229
    v_mul_f32 v133, v133, v229
    v_fmac_f32 v208, v132, v120
    v_fmac_f32 v209, v133, v122
    v_cvt_pk_bf16_f32 v146, v208, v209
    buffer_store_dword v146, v7, s[16:19], s26 offen
    s_waitcnt lgkmcnt(0)
    v_add_f32 v124, v124, v125
    v_add_f32 v126, v126, v127
    v_sub_f32 v132, v210, v230
    v_sub_f32 v133, v211, v230
    v_mul_f32 v132, v132, v231
    v_mul_f32 v133, v133, v231
    v_fmac_f32 v210, v132, v124
    v_fmac_f32 v211, v133, v126
    v_cvt_pk_bf16_f32 v147, v210, v211
    buffer_store_dword v147, v7, s[16:19], s27 offen
    s_endpgm
a_end:
    s_endpgm
.globl g_kernel
.p2align 8
.type g_kernel,@function
g_kernel:
    s_cmp_ge_u32 s2, 256
    s_cbranch_scc1 g_end
    s_load_dwordx2 s[12:13], s[0:1], 96
    s_load_dwordx4 s[4:7], s[0:1], 56
    s_load_dwordx4 s[8:11], s[0:1], 72
    v_and_b32 v1, 63, v0
    v_lshrrev_b32 v2, 6, v0
    s_nop 0
    v_readfirstlane_b32 s44, v2
    s_and_b32 s47, s2, 7
    s_lshr_b32 s48, s2, 3
    v_lshlrev_b32 v2, 4, v1
    s_lshl_b32 s40, s47, 2
    s_and_b32 s41, s48, 3
    s_add_u32 s40, s40, s41
    s_lshr_b32 s41, s48, 2
    s_mov_b32 s43, 0
    s_cmp_lt_u32 s48, 4
    s_cbranch_scc1 g_stats
    s_mov_b32 s43, 1
    s_sub_u32 s48, s48, 4
    s_and_b32 s45, s47, 1
    s_lshl_b32 s45, s45, 2
    s_and_b32 s49, s48, 3
    s_add_u32 s45, s45, s49
    s_lshr_b32 s46, s47, 1
    s_mul_i32 s46, s46, 7
    s_lshr_b32 s49, s48, 2
    s_add_u32 s46, s46, s49
    s_lshl_b32 s47, s45, 4
    s_lshl_b32 s48, s44, 2
    s_add_u32 s47, s47, s48
    s_lshl_b32 s49, s47, 14
    v_bfe_u32 v8, v1, 4, 2
    v_lshlrev_b32 v8, 1, v8
    v_and_b32 v3, 7, v1
    v_xor_b32 v3, v3, v8
    v_lshlrev_b32 v3, 4, v3
    v_lshrrev_b32 v8, 3, v1
    v_mul_u32_u24 v8, 3584, v8
    v_add_u32 v3, v3, v8
    s_lshl_b32 s50, s46, 7
    s_mul_i32 s51, s44, 28672
    s_add_u32 s50, s50, s51
    v_add_u32 v3, s50, v3
    s_lshl_b32 s52, s44, 10
    s_waitcnt lgkmcnt(0)
    s_mov_b32 s16, s4
    s_mov_b32 s17, s5
    s_mov_b32 s18, 1835008
    s_mov_b32 s19, 131072
    s_mov_b32 s24, s6
    s_mov_b32 s25, s7
    s_mov_b32 s26, 1835008
    s_mov_b32 s27, 131072
    s_add_u32 s50, s49, 4194304
    s_add_u32 s20, s12, s50
    s_addc_u32 s21, s13, 0
    s_mov_b32 s22, 65536
    s_mov_b32 s23, 131072
    v_add_u32 v4, 0, v2
    v_add_u32 v5, 16384, v2
    v_add_u32 v6, 32768, v2
    v_add_u32 v7, 49152, v2
    s_mov_b32 s53, 4096
    s_mov_b32 s54, 8192
    s_mov_b32 s55, 12288
    s_add_u32 m0, s52, 0
    s_mov_b32 s57, 0
    buffer_load_dwordx4 v3, s[16:19], s57 offen lds
    s_add_u32 m0, s52, 65536
    s_nop 0
    buffer_load_dwordx4 v3, s[24:27], s57 offen lds
    buffer_load_dwordx4 a[0:3], v4, s[20:23], 0 offen offset:0
    buffer_load_dwordx4 a[4:7], v5, s[20:23], 0 offen offset:0
    buffer_load_dwordx4 a[8:11], v6, s[20:23], 0 offen offset:0
    buffer_load_dwordx4 a[12:15], v7, s[20:23], 0 offen offset:0
    s_add_u32 m0, s52, 4096
    s_mov_b32 s57, 114688
    buffer_load_dwordx4 v3, s[16:19], s57 offen lds
    s_add_u32 m0, s52, 69632
    s_nop 0
    buffer_load_dwordx4 v3, s[24:27], s57 offen lds
    v_bfe_u32 v8, v1, 2, 2
    v_lshrrev_b32 v9, 4, v1
    v_lshl_add_u32 v8, v9, 2, v8
    v_bfe_u32 v9, v8, 1, 2
    v_lshlrev_b32 v9, 1, v9
    v_lshlrev_b32 v8, 7, v8
    v_and_b32 v10, 1, v1
    v_lshl_add_u32 v8, v10, 3, v8
    v_bfe_u32 v10, v1, 1, 1
    v_xor_b32 v9, v9, v10
    v_xor_b32 v208, 0, v9
    v_lshl_add_u32 v208, v208, 4, v8
    v_xor_b32 v209, 2, v9
    v_lshl_add_u32 v209, v209, 4, v8
    v_xor_b32 v210, 4, v9
    v_lshl_add_u32 v210, v210, 4, v8
    v_xor_b32 v211, 6, v9
    v_lshl_add_u32 v211, v211, 4, v8
    v_add_u32 v212, 65536, v208
    v_add_u32 v213, 65536, v209
    v_add_u32 v214, 65536, v210
    v_add_u32 v215, 65536, v211
    buffer_load_dwordx4 a[16:19], v4, s[20:23], 0 offen offset:1024
    buffer_load_dwordx4 a[20:23], v5, s[20:23], 0 offen offset:1024
    buffer_load_dwordx4 a[24:27], v6, s[20:23], 0 offen offset:1024
    buffer_load_dwordx4 a[28:31], v7, s[20:23], 0 offen offset:1024
    s_getpc_b64 s[60:61]
g_kernel_pf1:
    s_sub_u32 s60, s60, g_kernel_pf1-g_kernel
    s_subb_u32 s61, s61, 0
    s_lshr_b32 s62, s2, 3
    s_min_u32 s62, s62, ((code_end-g_kernel)>>10)-1
    s_lshl_b32 s62, s62, 10
    v_lshl_add_u32 v8, v1, 4, s62
    global_load_dwordx4 v[248:251], v8, s[60:61]
    s_add_u32 s28, s12, 6356992
    s_addc_u32 s29, s13, 0
    s_mov_b32 s30, 14336
    s_mov_b32 s31, 131072
    s_add_u32 s32, s12, 16777216
    s_addc_u32 s33, s13, 0
    s_mov_b32 s34, 7340032
    s_mov_b32 s35, 131072
    s_add_u32 s36, s12, 6422528
    s_addc_u32 s37, s13, 0
    s_mov_b32 s38, 16384
    s_mov_b32 s39, 131072
    s_add_u32 s14, s12, 6488064
    s_addc_u32 s15, s13, 0
    v_lshrrev_b32 v8, 4, v1
    v_lshlrev_b32 v8, 4, v8
    s_lshl_b32 s50, s46, 8
    v_add_u32 v8, s50, v8
    v_add_u32 v9, 7168, v8
    v_and_b32 v10, 15, v1
    v_lshlrev_b32 v10, 3, v10
    s_lshl_b32 s50, s47, 7
    v_add_u32 v10, s50, v10
    v_mov_b32 v11, 0
    s_mul_i32 s58, s41, 56
    s_mul_i32 s59, s44, 14
    s_add_u32 s58, s58, s59
    s_lshl_b32 s58, s58, 12
    s_add_u32 s58, s58, 12582912
    s_add_u32 s72, s12, s58
    s_addc_u32 s73, s13, 0
    s_mov_b32 s74, 57344
    s_mov_b32 s75, 131072
    s_waitcnt vmcnt(11)
    s_barrier
    ds_read_b64_tr_b16 v[144:145], v208 offset:0
    ds_read_b64_tr_b16 v[146:147], v208 offset:2048
    ds_read_b64_tr_b16 v[148:149], v212 offset:0
    ds_read_b64_tr_b16 v[150:151], v212 offset:2048
    ds_read_b64_tr_b16 v[152:153], v209 offset:0
    ds_read_b64_tr_b16 v[154:155], v209 offset:2048
    ds_read_b64_tr_b16 v[156:157], v213 offset:0
    ds_read_b64_tr_b16 v[158:159], v213 offset:2048
    ds_read_b64_tr_b16 v[160:161], v210 offset:0
    ds_read_b64_tr_b16 v[162:163], v210 offset:2048
    ds_read_b64_tr_b16 v[164:165], v214 offset:0
    ds_read_b64_tr_b16 v[166:167], v214 offset:2048
    s_waitcnt lgkmcnt(4)
    ds_read_b64_tr_b16 v[168:169], v211 offset:0
    ds_read_b64_tr_b16 v[170:171], v211 offset:2048
    ds_read_b64_tr_b16 v[172:173], v215 offset:0
    ds_read_b64_tr_b16 v[174:175], v215 offset:2048
    s_waitcnt vmcnt(7)
    s_waitcnt lgkmcnt(14)
    v_mfma_f32_16x16x32_bf16 v[16:19], v[144:147], a[0:3], 0
    s_add_u32 m0, s52, 8192
    s_mov_b32 s57, 229376
    v_mfma_f32_16x16x32_bf16 v[48:51], v[144:147], a[4:7], 0
    v_mfma_f32_16x16x32_bf16 v[80:83], v[144:147], a[8:11], 0
    buffer_load_dwordx4 v3, s[16:19], s57 offen lds
    v_mfma_f32_16x16x32_bf16 v[112:115], v[144:147], a[12:15], 0
    s_waitcnt lgkmcnt(12)
    v_mfma_f32_16x16x32_bf16 v[20:23], v[148:151], a[0:3], 0
    s_waitcnt vmcnt(6)
    s_barrier
    v_mfma_f32_16x16x32_bf16 v[52:55], v[148:151], a[4:7], 0
    ds_read_b64_tr_b16 v[176:177], v208 offset:4096
    v_mfma_f32_16x16x32_bf16 v[84:87], v[148:151], a[8:11], 0
    s_add_u32 m0, s52, 73728
    ds_read_b64_tr_b16 v[178:179], v208 offset:6144
    v_mfma_f32_16x16x32_bf16 v[116:119], v[148:151], a[12:15], 0
    s_waitcnt lgkmcnt(12)
    v_mfma_f32_16x16x32_bf16 v[24:27], v[152:155], a[0:3], 0
    buffer_load_dwordx4 v3, s[24:27], s57 offen lds
    ds_read_b64_tr_b16 v[180:181], v212 offset:4096
    v_mfma_f32_16x16x32_bf16 v[56:59], v[152:155], a[4:7], 0
    v_mfma_f32_16x16x32_bf16 v[88:91], v[152:155], a[8:11], 0
    ds_read_b64_tr_b16 v[182:183], v212 offset:6144
    v_mfma_f32_16x16x32_bf16 v[120:123], v[152:155], a[12:15], 0
    ds_read_b64_tr_b16 v[184:185], v209 offset:4096
    s_waitcnt lgkmcnt(13)
    v_mfma_f32_16x16x32_bf16 v[28:31], v[156:159], a[0:3], 0
    buffer_load_dwordx4 a[32:35], v4, s[20:23], 0 offen offset:2048
    v_mfma_f32_16x16x32_bf16 v[60:63], v[156:159], a[4:7], 0
    ds_read_b64_tr_b16 v[186:187], v209 offset:6144
    v_mfma_f32_16x16x32_bf16 v[92:95], v[156:159], a[8:11], 0
    buffer_load_dwordx4 a[36:39], v5, s[20:23], 0 offen offset:2048
    v_mfma_f32_16x16x32_bf16 v[124:127], v[156:159], a[12:15], 0
    ds_read_b64_tr_b16 v[188:189], v213 offset:4096
    s_waitcnt lgkmcnt(13)
    v_mfma_f32_16x16x32_bf16 v[32:35], v[160:163], a[0:3], 0
    buffer_load_dwordx4 a[40:43], v6, s[20:23], 0 offen offset:2048
    v_mfma_f32_16x16x32_bf16 v[64:67], v[160:163], a[4:7], 0
    ds_read_b64_tr_b16 v[190:191], v213 offset:6144
    v_mfma_f32_16x16x32_bf16 v[96:99], v[160:163], a[8:11], 0
    buffer_load_dwordx4 a[44:47], v7, s[20:23], 0 offen offset:2048
    ds_read_b64_tr_b16 v[192:193], v210 offset:4096
    v_mfma_f32_16x16x32_bf16 v[128:131], v[160:163], a[12:15], 0
    s_waitcnt lgkmcnt(13)
    v_mfma_f32_16x16x32_bf16 v[36:39], v[164:167], a[0:3], 0
    ds_read_b64_tr_b16 v[194:195], v210 offset:6144
    v_mfma_f32_16x16x32_bf16 v[68:71], v[164:167], a[4:7], 0
    v_mfma_f32_16x16x32_bf16 v[100:103], v[164:167], a[8:11], 0
    s_add_u32 m0, s52, 12288
    s_mov_b32 s57, 344064
    ds_read_b64_tr_b16 v[196:197], v214 offset:4096
    v_mfma_f32_16x16x32_bf16 v[132:135], v[164:167], a[12:15], 0
    s_waitcnt lgkmcnt(13)
    v_mfma_f32_16x16x32_bf16 v[40:43], v[168:171], a[0:3], 0
    buffer_load_dwordx4 v3, s[16:19], s57 offen lds
    ds_read_b64_tr_b16 v[198:199], v214 offset:6144
    v_mfma_f32_16x16x32_bf16 v[72:75], v[168:171], a[4:7], 0
    ds_read_b64_tr_b16 v[200:201], v211 offset:4096
    v_mfma_f32_16x16x32_bf16 v[104:107], v[168:171], a[8:11], 0
    s_add_u32 m0, s52, 77824
    v_mfma_f32_16x16x32_bf16 v[136:139], v[168:171], a[12:15], 0
    ds_read_b64_tr_b16 v[202:203], v211 offset:6144
    s_waitcnt lgkmcnt(14)
    v_mfma_f32_16x16x32_bf16 v[44:47], v[172:175], a[0:3], 0
    buffer_load_dwordx4 v3, s[24:27], s57 offen lds
    v_mfma_f32_16x16x32_bf16 v[76:79], v[172:175], a[4:7], 0
    ds_read_b64_tr_b16 v[204:205], v215 offset:4096
    v_mfma_f32_16x16x32_bf16 v[108:111], v[172:175], a[8:11], 0
    v_mfma_f32_16x16x32_bf16 v[140:143], v[172:175], a[12:15], 0
    ds_read_b64_tr_b16 v[206:207], v215 offset:6144
    s_waitcnt vmcnt(9)
    s_waitcnt lgkmcnt(14)
    v_mfma_f32_16x16x32_bf16 v[16:19], v[176:179], a[16:19], v[16:19]
    buffer_load_dwordx4 a[48:51], v4, s[20:23], 0 offen offset:3072
    v_mfma_f32_16x16x32_bf16 v[48:51], v[176:179], a[20:23], v[48:51]
    v_mfma_f32_16x16x32_bf16 v[80:83], v[176:179], a[24:27], v[80:83]
    buffer_load_dwordx4 a[52:55], v5, s[20:23], 0 offen offset:3072
    v_mfma_f32_16x16x32_bf16 v[112:115], v[176:179], a[28:31], v[112:115]
    s_waitcnt lgkmcnt(12)
    v_mfma_f32_16x16x32_bf16 v[20:23], v[180:183], a[16:19], v[20:23]
    s_waitcnt vmcnt(8)
    s_barrier
    v_mfma_f32_16x16x32_bf16 v[52:55], v[180:183], a[20:23], v[52:55]
    ds_read_b64_tr_b16 v[144:145], v208 offset:8192
    v_mfma_f32_16x16x32_bf16 v[84:87], v[180:183], a[24:27], v[84:87]
    buffer_load_dwordx4 a[56:59], v6, s[20:23], 0 offen offset:3072
    ds_read_b64_tr_b16 v[146:147], v208 offset:10240
    v_mfma_f32_16x16x32_bf16 v[116:119], v[180:183], a[28:31], v[116:119]
    s_waitcnt lgkmcnt(12)
    v_mfma_f32_16x16x32_bf16 v[24:27], v[184:187], a[16:19], v[24:27]
    buffer_load_dwordx4 a[60:63], v7, s[20:23], 0 offen offset:3072
    ds_read_b64_tr_b16 v[148:149], v212 offset:8192
    v_mfma_f32_16x16x32_bf16 v[56:59], v[184:187], a[20:23], v[56:59]
    v_mfma_f32_16x16x32_bf16 v[88:91], v[184:187], a[24:27], v[88:91]
    ds_read_b64_tr_b16 v[150:151], v212 offset:10240
    v_mfma_f32_16x16x32_bf16 v[120:123], v[184:187], a[28:31], v[120:123]
    ds_read_b64_tr_b16 v[152:153], v209 offset:8192
    s_waitcnt lgkmcnt(13)
    v_mfma_f32_16x16x32_bf16 v[28:31], v[188:191], a[16:19], v[28:31]
    s_add_u32 m0, s52, 16384
    s_mov_b32 s57, 458752
    v_mfma_f32_16x16x32_bf16 v[60:63], v[188:191], a[20:23], v[60:63]
    ds_read_b64_tr_b16 v[154:155], v209 offset:10240
    v_mfma_f32_16x16x32_bf16 v[92:95], v[188:191], a[24:27], v[92:95]
    buffer_load_dwordx4 v3, s[16:19], s57 offen lds
    v_mfma_f32_16x16x32_bf16 v[124:127], v[188:191], a[28:31], v[124:127]
    ds_read_b64_tr_b16 v[156:157], v213 offset:8192
    s_waitcnt lgkmcnt(13)
    v_mfma_f32_16x16x32_bf16 v[32:35], v[192:195], a[16:19], v[32:35]
    s_add_u32 m0, s52, 81920
    v_mfma_f32_16x16x32_bf16 v[64:67], v[192:195], a[20:23], v[64:67]
    ds_read_b64_tr_b16 v[158:159], v213 offset:10240
    v_mfma_f32_16x16x32_bf16 v[96:99], v[192:195], a[24:27], v[96:99]
    buffer_load_dwordx4 v3, s[24:27], s57 offen lds
    ds_read_b64_tr_b16 v[160:161], v210 offset:8192
    v_mfma_f32_16x16x32_bf16 v[128:131], v[192:195], a[28:31], v[128:131]
    s_waitcnt lgkmcnt(13)
    v_mfma_f32_16x16x32_bf16 v[36:39], v[196:199], a[16:19], v[36:39]
    ds_read_b64_tr_b16 v[162:163], v210 offset:10240
    v_mfma_f32_16x16x32_bf16 v[68:71], v[196:199], a[20:23], v[68:71]
    v_mfma_f32_16x16x32_bf16 v[100:103], v[196:199], a[24:27], v[100:103]
    buffer_load_dwordx4 a[64:67], v4, s[20:23], s53 offen offset:0
    ds_read_b64_tr_b16 v[164:165], v214 offset:8192
    v_mfma_f32_16x16x32_bf16 v[132:135], v[196:199], a[28:31], v[132:135]
    s_waitcnt lgkmcnt(13)
    v_mfma_f32_16x16x32_bf16 v[40:43], v[200:203], a[16:19], v[40:43]
    buffer_load_dwordx4 a[68:71], v5, s[20:23], s53 offen offset:0
    ds_read_b64_tr_b16 v[166:167], v214 offset:10240
    v_mfma_f32_16x16x32_bf16 v[72:75], v[200:203], a[20:23], v[72:75]
    ds_read_b64_tr_b16 v[168:169], v211 offset:8192
    v_mfma_f32_16x16x32_bf16 v[104:107], v[200:203], a[24:27], v[104:107]
    buffer_load_dwordx4 a[72:75], v6, s[20:23], s53 offen offset:0
    v_mfma_f32_16x16x32_bf16 v[136:139], v[200:203], a[28:31], v[136:139]
    ds_read_b64_tr_b16 v[170:171], v211 offset:10240
    s_waitcnt lgkmcnt(14)
    v_mfma_f32_16x16x32_bf16 v[44:47], v[204:207], a[16:19], v[44:47]
    buffer_load_dwordx4 a[76:79], v7, s[20:23], s53 offen offset:0
    v_mfma_f32_16x16x32_bf16 v[76:79], v[204:207], a[20:23], v[76:79]
    ds_read_b64_tr_b16 v[172:173], v215 offset:8192
    v_mfma_f32_16x16x32_bf16 v[108:111], v[204:207], a[24:27], v[108:111]
    v_mfma_f32_16x16x32_bf16 v[140:143], v[204:207], a[28:31], v[140:143]
    ds_read_b64_tr_b16 v[174:175], v215 offset:10240
    s_waitcnt vmcnt(12)
    s_waitcnt lgkmcnt(14)
    v_mfma_f32_16x16x32_bf16 v[16:19], v[144:147], a[32:35], v[16:19]
    s_add_u32 m0, s52, 20480
    s_mov_b32 s57, 573440
    v_mfma_f32_16x16x32_bf16 v[48:51], v[144:147], a[36:39], v[48:51]
    v_mfma_f32_16x16x32_bf16 v[80:83], v[144:147], a[40:43], v[80:83]
    buffer_load_dwordx4 v3, s[16:19], s57 offen lds
    v_mfma_f32_16x16x32_bf16 v[112:115], v[144:147], a[44:47], v[112:115]
    s_waitcnt lgkmcnt(12)
    v_mfma_f32_16x16x32_bf16 v[20:23], v[148:151], a[32:35], v[20:23]
    s_waitcnt vmcnt(11)
    s_barrier
    v_mfma_f32_16x16x32_bf16 v[52:55], v[148:151], a[36:39], v[52:55]
    ds_read_b64_tr_b16 v[176:177], v208 offset:12288
    v_mfma_f32_16x16x32_bf16 v[84:87], v[148:151], a[40:43], v[84:87]
    s_add_u32 m0, s52, 86016
    ds_read_b64_tr_b16 v[178:179], v208 offset:14336
    v_mfma_f32_16x16x32_bf16 v[116:119], v[148:151], a[44:47], v[116:119]
    s_waitcnt lgkmcnt(12)
    v_mfma_f32_16x16x32_bf16 v[24:27], v[152:155], a[32:35], v[24:27]
    buffer_load_dwordx4 v3, s[24:27], s57 offen lds
    ds_read_b64_tr_b16 v[180:181], v212 offset:12288
    v_mfma_f32_16x16x32_bf16 v[56:59], v[152:155], a[36:39], v[56:59]
    v_mfma_f32_16x16x32_bf16 v[88:91], v[152:155], a[40:43], v[88:91]
    ds_read_b64_tr_b16 v[182:183], v212 offset:14336
    v_mfma_f32_16x16x32_bf16 v[120:123], v[152:155], a[44:47], v[120:123]
    ds_read_b64_tr_b16 v[184:185], v209 offset:12288
    s_waitcnt lgkmcnt(13)
    v_mfma_f32_16x16x32_bf16 v[28:31], v[156:159], a[32:35], v[28:31]
    s_add_u32 m0, s52, 24576
    s_mov_b32 s57, 688128
    v_mfma_f32_16x16x32_bf16 v[60:63], v[156:159], a[36:39], v[60:63]
    ds_read_b64_tr_b16 v[186:187], v209 offset:14336
    v_mfma_f32_16x16x32_bf16 v[92:95], v[156:159], a[40:43], v[92:95]
    buffer_load_dwordx4 v3, s[16:19], s57 offen lds
    v_mfma_f32_16x16x32_bf16 v[124:127], v[156:159], a[44:47], v[124:127]
    ds_read_b64_tr_b16 v[188:189], v213 offset:12288
    s_waitcnt lgkmcnt(13)
    v_mfma_f32_16x16x32_bf16 v[32:35], v[160:163], a[32:35], v[32:35]
    s_add_u32 m0, s52, 90112
    v_mfma_f32_16x16x32_bf16 v[64:67], v[160:163], a[36:39], v[64:67]
    ds_read_b64_tr_b16 v[190:191], v213 offset:14336
    v_mfma_f32_16x16x32_bf16 v[96:99], v[160:163], a[40:43], v[96:99]
    buffer_load_dwordx4 v3, s[24:27], s57 offen lds
    ds_read_b64_tr_b16 v[192:193], v210 offset:12288
    v_mfma_f32_16x16x32_bf16 v[128:131], v[160:163], a[44:47], v[128:131]
    s_waitcnt lgkmcnt(13)
    v_mfma_f32_16x16x32_bf16 v[36:39], v[164:167], a[32:35], v[36:39]
    ds_read_b64_tr_b16 v[194:195], v210 offset:14336
    v_mfma_f32_16x16x32_bf16 v[68:71], v[164:167], a[36:39], v[68:71]
    v_mfma_f32_16x16x32_bf16 v[100:103], v[164:167], a[40:43], v[100:103]
    buffer_load_dwordx4 a[80:83], v4, s[20:23], s53 offen offset:1024
    ds_read_b64_tr_b16 v[196:197], v214 offset:12288
    v_mfma_f32_16x16x32_bf16 v[132:135], v[164:167], a[44:47], v[132:135]
    s_waitcnt lgkmcnt(13)
    v_mfma_f32_16x16x32_bf16 v[40:43], v[168:171], a[32:35], v[40:43]
    buffer_load_dwordx4 a[84:87], v5, s[20:23], s53 offen offset:1024
    ds_read_b64_tr_b16 v[198:199], v214 offset:14336
    v_mfma_f32_16x16x32_bf16 v[72:75], v[168:171], a[36:39], v[72:75]
    ds_read_b64_tr_b16 v[200:201], v211 offset:12288
    v_mfma_f32_16x16x32_bf16 v[104:107], v[168:171], a[40:43], v[104:107]
    buffer_load_dwordx4 a[88:91], v6, s[20:23], s53 offen offset:1024
    v_mfma_f32_16x16x32_bf16 v[136:139], v[168:171], a[44:47], v[136:139]
    ds_read_b64_tr_b16 v[202:203], v211 offset:14336
    s_waitcnt lgkmcnt(14)
    v_mfma_f32_16x16x32_bf16 v[44:47], v[172:175], a[32:35], v[44:47]
    buffer_load_dwordx4 a[92:95], v7, s[20:23], s53 offen offset:1024
    v_mfma_f32_16x16x32_bf16 v[76:79], v[172:175], a[36:39], v[76:79]
    ds_read_b64_tr_b16 v[204:205], v215 offset:12288
    v_mfma_f32_16x16x32_bf16 v[108:111], v[172:175], a[40:43], v[108:111]
    v_mfma_f32_16x16x32_bf16 v[140:143], v[172:175], a[44:47], v[140:143]
    ds_read_b64_tr_b16 v[206:207], v215 offset:14336
    s_waitcnt vmcnt(14)
    s_waitcnt lgkmcnt(14)
    v_mfma_f32_16x16x32_bf16 v[16:19], v[176:179], a[48:51], v[16:19]
    s_add_u32 m0, s52, 28672
    s_mov_b32 s57, 802816
    v_mfma_f32_16x16x32_bf16 v[48:51], v[176:179], a[52:55], v[48:51]
    v_mfma_f32_16x16x32_bf16 v[80:83], v[176:179], a[56:59], v[80:83]
    buffer_load_dwordx4 v3, s[16:19], s57 offen lds
    v_mfma_f32_16x16x32_bf16 v[112:115], v[176:179], a[60:63], v[112:115]
    s_waitcnt lgkmcnt(12)
    v_mfma_f32_16x16x32_bf16 v[20:23], v[180:183], a[48:51], v[20:23]
    s_waitcnt vmcnt(13)
    s_barrier
    v_mfma_f32_16x16x32_bf16 v[52:55], v[180:183], a[52:55], v[52:55]
    ds_read_b64_tr_b16 v[144:145], v208 offset:16384
    v_mfma_f32_16x16x32_bf16 v[84:87], v[180:183], a[56:59], v[84:87]
    s_add_u32 m0, s52, 94208
    ds_read_b64_tr_b16 v[146:147], v208 offset:18432
    v_mfma_f32_16x16x32_bf16 v[116:119], v[180:183], a[60:63], v[116:119]
    s_waitcnt lgkmcnt(12)
    v_mfma_f32_16x16x32_bf16 v[24:27], v[184:187], a[48:51], v[24:27]
    buffer_load_dwordx4 v3, s[24:27], s57 offen lds
    ds_read_b64_tr_b16 v[148:149], v212 offset:16384
    v_mfma_f32_16x16x32_bf16 v[56:59], v[184:187], a[52:55], v[56:59]
    v_mfma_f32_16x16x32_bf16 v[88:91], v[184:187], a[56:59], v[88:91]
    ds_read_b64_tr_b16 v[150:151], v212 offset:18432
    v_mfma_f32_16x16x32_bf16 v[120:123], v[184:187], a[60:63], v[120:123]
    ds_read_b64_tr_b16 v[152:153], v209 offset:16384
    s_waitcnt lgkmcnt(13)
    v_mfma_f32_16x16x32_bf16 v[28:31], v[188:191], a[48:51], v[28:31]
    buffer_load_dwordx4 a[96:99], v4, s[20:23], s53 offen offset:2048
    v_mfma_f32_16x16x32_bf16 v[60:63], v[188:191], a[52:55], v[60:63]
    ds_read_b64_tr_b16 v[154:155], v209 offset:18432
    v_mfma_f32_16x16x32_bf16 v[92:95], v[188:191], a[56:59], v[92:95]
    buffer_load_dwordx4 a[100:103], v5, s[20:23], s53 offen offset:2048
    v_mfma_f32_16x16x32_bf16 v[124:127], v[188:191], a[60:63], v[124:127]
    ds_read_b64_tr_b16 v[156:157], v213 offset:16384
    s_waitcnt lgkmcnt(13)
    v_mfma_f32_16x16x32_bf16 v[32:35], v[192:195], a[48:51], v[32:35]
    buffer_load_dwordx4 a[104:107], v6, s[20:23], s53 offen offset:2048
    v_mfma_f32_16x16x32_bf16 v[64:67], v[192:195], a[52:55], v[64:67]
    ds_read_b64_tr_b16 v[158:159], v213 offset:18432
    v_mfma_f32_16x16x32_bf16 v[96:99], v[192:195], a[56:59], v[96:99]
    buffer_load_dwordx4 a[108:111], v7, s[20:23], s53 offen offset:2048
    ds_read_b64_tr_b16 v[160:161], v210 offset:16384
    v_mfma_f32_16x16x32_bf16 v[128:131], v[192:195], a[60:63], v[128:131]
    s_waitcnt lgkmcnt(13)
    v_mfma_f32_16x16x32_bf16 v[36:39], v[196:199], a[48:51], v[36:39]
    ds_read_b64_tr_b16 v[162:163], v210 offset:18432
    v_mfma_f32_16x16x32_bf16 v[68:71], v[196:199], a[52:55], v[68:71]
    v_mfma_f32_16x16x32_bf16 v[100:103], v[196:199], a[56:59], v[100:103]
    s_add_u32 m0, s52, 32768
    s_mov_b32 s57, 917504
    ds_read_b64_tr_b16 v[164:165], v214 offset:16384
    v_mfma_f32_16x16x32_bf16 v[132:135], v[196:199], a[60:63], v[132:135]
    s_waitcnt lgkmcnt(13)
    v_mfma_f32_16x16x32_bf16 v[40:43], v[200:203], a[48:51], v[40:43]
    buffer_load_dwordx4 v3, s[16:19], s57 offen lds
    ds_read_b64_tr_b16 v[166:167], v214 offset:18432
    v_mfma_f32_16x16x32_bf16 v[72:75], v[200:203], a[52:55], v[72:75]
    ds_read_b64_tr_b16 v[168:169], v211 offset:16384
    v_mfma_f32_16x16x32_bf16 v[104:107], v[200:203], a[56:59], v[104:107]
    s_add_u32 m0, s52, 98304
    v_mfma_f32_16x16x32_bf16 v[136:139], v[200:203], a[60:63], v[136:139]
    ds_read_b64_tr_b16 v[170:171], v211 offset:18432
    s_waitcnt lgkmcnt(14)
    v_mfma_f32_16x16x32_bf16 v[44:47], v[204:207], a[48:51], v[44:47]
    buffer_load_dwordx4 v3, s[24:27], s57 offen lds
    v_mfma_f32_16x16x32_bf16 v[76:79], v[204:207], a[52:55], v[76:79]
    ds_read_b64_tr_b16 v[172:173], v215 offset:16384
    v_mfma_f32_16x16x32_bf16 v[108:111], v[204:207], a[56:59], v[108:111]
    v_mfma_f32_16x16x32_bf16 v[140:143], v[204:207], a[60:63], v[140:143]
    ds_read_b64_tr_b16 v[174:175], v215 offset:18432
    s_waitcnt vmcnt(16)
    s_waitcnt lgkmcnt(14)
    v_mfma_f32_16x16x32_bf16 v[16:19], v[144:147], a[64:67], v[16:19]
    s_add_u32 m0, s52, 36864
    s_mov_b32 s57, 1032192
    v_mfma_f32_16x16x32_bf16 v[48:51], v[144:147], a[68:71], v[48:51]
    v_mfma_f32_16x16x32_bf16 v[80:83], v[144:147], a[72:75], v[80:83]
    buffer_load_dwordx4 v3, s[16:19], s57 offen lds
    v_mfma_f32_16x16x32_bf16 v[112:115], v[144:147], a[76:79], v[112:115]
    s_waitcnt lgkmcnt(12)
    v_mfma_f32_16x16x32_bf16 v[20:23], v[148:151], a[64:67], v[20:23]
    s_waitcnt vmcnt(15)
    s_barrier
    v_mfma_f32_16x16x32_bf16 v[52:55], v[148:151], a[68:71], v[52:55]
    ds_read_b64_tr_b16 v[176:177], v208 offset:20480
    v_mfma_f32_16x16x32_bf16 v[84:87], v[148:151], a[72:75], v[84:87]
    s_add_u32 m0, s52, 102400
    ds_read_b64_tr_b16 v[178:179], v208 offset:22528
    v_mfma_f32_16x16x32_bf16 v[116:119], v[148:151], a[76:79], v[116:119]
    s_waitcnt lgkmcnt(12)
    v_mfma_f32_16x16x32_bf16 v[24:27], v[152:155], a[64:67], v[24:27]
    buffer_load_dwordx4 v3, s[24:27], s57 offen lds
    ds_read_b64_tr_b16 v[180:181], v212 offset:20480
    v_mfma_f32_16x16x32_bf16 v[56:59], v[152:155], a[68:71], v[56:59]
    v_mfma_f32_16x16x32_bf16 v[88:91], v[152:155], a[72:75], v[88:91]
    ds_read_b64_tr_b16 v[182:183], v212 offset:22528
    v_mfma_f32_16x16x32_bf16 v[120:123], v[152:155], a[76:79], v[120:123]
    ds_read_b64_tr_b16 v[184:185], v209 offset:20480
    s_waitcnt lgkmcnt(13)
    v_mfma_f32_16x16x32_bf16 v[28:31], v[156:159], a[64:67], v[28:31]
    buffer_load_dwordx4 a[112:115], v4, s[20:23], s53 offen offset:3072
    v_mfma_f32_16x16x32_bf16 v[60:63], v[156:159], a[68:71], v[60:63]
    ds_read_b64_tr_b16 v[186:187], v209 offset:22528
    v_mfma_f32_16x16x32_bf16 v[92:95], v[156:159], a[72:75], v[92:95]
    buffer_load_dwordx4 a[116:119], v5, s[20:23], s53 offen offset:3072
    v_mfma_f32_16x16x32_bf16 v[124:127], v[156:159], a[76:79], v[124:127]
    ds_read_b64_tr_b16 v[188:189], v213 offset:20480
    s_waitcnt lgkmcnt(13)
    v_mfma_f32_16x16x32_bf16 v[32:35], v[160:163], a[64:67], v[32:35]
    buffer_load_dwordx4 a[120:123], v6, s[20:23], s53 offen offset:3072
    v_mfma_f32_16x16x32_bf16 v[64:67], v[160:163], a[68:71], v[64:67]
    ds_read_b64_tr_b16 v[190:191], v213 offset:22528
    v_mfma_f32_16x16x32_bf16 v[96:99], v[160:163], a[72:75], v[96:99]
    buffer_load_dwordx4 a[124:127], v7, s[20:23], s53 offen offset:3072
    ds_read_b64_tr_b16 v[192:193], v210 offset:20480
    v_mfma_f32_16x16x32_bf16 v[128:131], v[160:163], a[76:79], v[128:131]
    s_waitcnt lgkmcnt(13)
    v_mfma_f32_16x16x32_bf16 v[36:39], v[164:167], a[64:67], v[36:39]
    ds_read_b64_tr_b16 v[194:195], v210 offset:22528
    v_mfma_f32_16x16x32_bf16 v[68:71], v[164:167], a[68:71], v[68:71]
    v_mfma_f32_16x16x32_bf16 v[100:103], v[164:167], a[72:75], v[100:103]
    s_add_u32 m0, s52, 40960
    s_mov_b32 s57, 1146880
    ds_read_b64_tr_b16 v[196:197], v214 offset:20480
    v_mfma_f32_16x16x32_bf16 v[132:135], v[164:167], a[76:79], v[132:135]
    s_waitcnt lgkmcnt(13)
    v_mfma_f32_16x16x32_bf16 v[40:43], v[168:171], a[64:67], v[40:43]
    buffer_load_dwordx4 v3, s[16:19], s57 offen lds
    ds_read_b64_tr_b16 v[198:199], v214 offset:22528
    v_mfma_f32_16x16x32_bf16 v[72:75], v[168:171], a[68:71], v[72:75]
    ds_read_b64_tr_b16 v[200:201], v211 offset:20480
    v_mfma_f32_16x16x32_bf16 v[104:107], v[168:171], a[72:75], v[104:107]
    s_add_u32 m0, s52, 106496
    v_mfma_f32_16x16x32_bf16 v[136:139], v[168:171], a[76:79], v[136:139]
    ds_read_b64_tr_b16 v[202:203], v211 offset:22528
    s_waitcnt lgkmcnt(14)
    v_mfma_f32_16x16x32_bf16 v[44:47], v[172:175], a[64:67], v[44:47]
    buffer_load_dwordx4 v3, s[24:27], s57 offen lds
    v_mfma_f32_16x16x32_bf16 v[76:79], v[172:175], a[68:71], v[76:79]
    ds_read_b64_tr_b16 v[204:205], v215 offset:20480
    v_mfma_f32_16x16x32_bf16 v[108:111], v[172:175], a[72:75], v[108:111]
    v_mfma_f32_16x16x32_bf16 v[140:143], v[172:175], a[76:79], v[140:143]
    ds_read_b64_tr_b16 v[206:207], v215 offset:22528
    s_waitcnt vmcnt(16)
    s_waitcnt lgkmcnt(14)
    v_mfma_f32_16x16x32_bf16 v[16:19], v[176:179], a[80:83], v[16:19]
    s_add_u32 m0, s52, 45056
    s_mov_b32 s57, 1261568
    v_mfma_f32_16x16x32_bf16 v[48:51], v[176:179], a[84:87], v[48:51]
    v_mfma_f32_16x16x32_bf16 v[80:83], v[176:179], a[88:91], v[80:83]
    buffer_load_dwordx4 v3, s[16:19], s57 offen lds
    v_mfma_f32_16x16x32_bf16 v[112:115], v[176:179], a[92:95], v[112:115]
    s_waitcnt lgkmcnt(12)
    v_mfma_f32_16x16x32_bf16 v[20:23], v[180:183], a[80:83], v[20:23]
    s_waitcnt vmcnt(15)
    s_barrier
    v_mfma_f32_16x16x32_bf16 v[52:55], v[180:183], a[84:87], v[52:55]
    ds_read_b64_tr_b16 v[144:145], v208 offset:24576
    v_mfma_f32_16x16x32_bf16 v[84:87], v[180:183], a[88:91], v[84:87]
    ds_read_b64_tr_b16 v[146:147], v208 offset:26624
    v_mfma_f32_16x16x32_bf16 v[116:119], v[180:183], a[92:95], v[116:119]
    s_waitcnt lgkmcnt(12)
    v_mfma_f32_16x16x32_bf16 v[24:27], v[184:187], a[80:83], v[24:27]
    s_add_u32 m0, s52, 110592
    ds_read_b64_tr_b16 v[148:149], v212 offset:24576
    v_mfma_f32_16x16x32_bf16 v[56:59], v[184:187], a[84:87], v[56:59]
    v_mfma_f32_16x16x32_bf16 v[88:91], v[184:187], a[88:91], v[88:91]
    ds_read_b64_tr_b16 v[150:151], v212 offset:26624
    v_mfma_f32_16x16x32_bf16 v[120:123], v[184:187], a[92:95], v[120:123]
    ds_read_b64_tr_b16 v[152:153], v209 offset:24576
    s_waitcnt lgkmcnt(13)
    v_mfma_f32_16x16x32_bf16 v[28:31], v[188:191], a[80:83], v[28:31]
    buffer_load_dwordx4 v3, s[24:27], s57 offen lds
    v_mfma_f32_16x16x32_bf16 v[60:63], v[188:191], a[84:87], v[60:63]
    ds_read_b64_tr_b16 v[154:155], v209 offset:26624
    v_mfma_f32_16x16x32_bf16 v[92:95], v[188:191], a[88:91], v[92:95]
    v_mfma_f32_16x16x32_bf16 v[124:127], v[188:191], a[92:95], v[124:127]
    ds_read_b64_tr_b16 v[156:157], v213 offset:24576
    s_waitcnt lgkmcnt(13)
    v_mfma_f32_16x16x32_bf16 v[32:35], v[192:195], a[80:83], v[32:35]
    buffer_load_dwordx4 a[128:131], v4, s[20:23], s54 offen offset:0
    v_mfma_f32_16x16x32_bf16 v[64:67], v[192:195], a[84:87], v[64:67]
    ds_read_b64_tr_b16 v[158:159], v213 offset:26624
    v_mfma_f32_16x16x32_bf16 v[96:99], v[192:195], a[88:91], v[96:99]
    ds_read_b64_tr_b16 v[160:161], v210 offset:24576
    v_mfma_f32_16x16x32_bf16 v[128:131], v[192:195], a[92:95], v[128:131]
    s_waitcnt lgkmcnt(13)
    v_mfma_f32_16x16x32_bf16 v[36:39], v[196:199], a[80:83], v[36:39]
    buffer_load_dwordx4 a[132:135], v5, s[20:23], s54 offen offset:0
    ds_read_b64_tr_b16 v[162:163], v210 offset:26624
    v_mfma_f32_16x16x32_bf16 v[68:71], v[196:199], a[84:87], v[68:71]
    v_mfma_f32_16x16x32_bf16 v[100:103], v[196:199], a[88:91], v[100:103]
    ds_read_b64_tr_b16 v[164:165], v214 offset:24576
    v_mfma_f32_16x16x32_bf16 v[132:135], v[196:199], a[92:95], v[132:135]
    s_waitcnt lgkmcnt(13)
    v_mfma_f32_16x16x32_bf16 v[40:43], v[200:203], a[80:83], v[40:43]
    buffer_load_dwordx4 a[136:139], v6, s[20:23], s54 offen offset:0
    ds_read_b64_tr_b16 v[166:167], v214 offset:26624
    v_mfma_f32_16x16x32_bf16 v[72:75], v[200:203], a[84:87], v[72:75]
    ds_read_b64_tr_b16 v[168:169], v211 offset:24576
    v_mfma_f32_16x16x32_bf16 v[104:107], v[200:203], a[88:91], v[104:107]
    v_mfma_f32_16x16x32_bf16 v[136:139], v[200:203], a[92:95], v[136:139]
    ds_read_b64_tr_b16 v[170:171], v211 offset:26624
    s_waitcnt lgkmcnt(14)
    v_mfma_f32_16x16x32_bf16 v[44:47], v[204:207], a[80:83], v[44:47]
    buffer_load_dwordx4 a[140:143], v7, s[20:23], s54 offen offset:0
    v_mfma_f32_16x16x32_bf16 v[76:79], v[204:207], a[84:87], v[76:79]
    ds_read_b64_tr_b16 v[172:173], v215 offset:24576
    v_mfma_f32_16x16x32_bf16 v[108:111], v[204:207], a[88:91], v[108:111]
    v_mfma_f32_16x16x32_bf16 v[140:143], v[204:207], a[92:95], v[140:143]
    ds_read_b64_tr_b16 v[174:175], v215 offset:26624
    s_waitcnt vmcnt(16)
    s_waitcnt lgkmcnt(14)
    v_mfma_f32_16x16x32_bf16 v[16:19], v[144:147], a[96:99], v[16:19]
    s_add_u32 m0, s52, 49152
    s_mov_b32 s57, 1376256
    v_mfma_f32_16x16x32_bf16 v[48:51], v[144:147], a[100:103], v[48:51]
    ds_read_b64_tr_b16 v[176:177], v208 offset:28672
    v_mfma_f32_16x16x32_bf16 v[80:83], v[144:147], a[104:107], v[80:83]
    v_mfma_f32_16x16x32_bf16 v[112:115], v[144:147], a[108:111], v[112:115]
    ds_read_b64_tr_b16 v[178:179], v208 offset:30720
    s_waitcnt lgkmcnt(14)
    v_mfma_f32_16x16x32_bf16 v[20:23], v[148:151], a[96:99], v[20:23]
    buffer_load_dwordx4 v3, s[16:19], s57 offen lds
    v_mfma_f32_16x16x32_bf16 v[52:55], v[148:151], a[100:103], v[52:55]
    ds_read_b64_tr_b16 v[180:181], v212 offset:28672
    v_mfma_f32_16x16x32_bf16 v[84:87], v[148:151], a[104:107], v[84:87]
    v_mfma_f32_16x16x32_bf16 v[116:119], v[148:151], a[108:111], v[116:119]
    ds_read_b64_tr_b16 v[182:183], v212 offset:30720
    s_waitcnt lgkmcnt(14)
    v_mfma_f32_16x16x32_bf16 v[24:27], v[152:155], a[96:99], v[24:27]
    s_add_u32 m0, s52, 114688
    v_mfma_f32_16x16x32_bf16 v[56:59], v[152:155], a[100:103], v[56:59]
    ds_read_b64_tr_b16 v[184:185], v209 offset:28672
    v_mfma_f32_16x16x32_bf16 v[88:91], v[152:155], a[104:107], v[88:91]
    v_mfma_f32_16x16x32_bf16 v[120:123], v[152:155], a[108:111], v[120:123]
    ds_read_b64_tr_b16 v[186:187], v209 offset:30720
    s_waitcnt lgkmcnt(14)
    v_mfma_f32_16x16x32_bf16 v[28:31], v[156:159], a[96:99], v[28:31]
    buffer_load_dwordx4 v3, s[24:27], s57 offen lds
    v_mfma_f32_16x16x32_bf16 v[60:63], v[156:159], a[100:103], v[60:63]
    ds_read_b64_tr_b16 v[188:189], v213 offset:28672
    v_mfma_f32_16x16x32_bf16 v[92:95], v[156:159], a[104:107], v[92:95]
    v_mfma_f32_16x16x32_bf16 v[124:127], v[156:159], a[108:111], v[124:127]
    ds_read_b64_tr_b16 v[190:191], v213 offset:30720
    s_waitcnt lgkmcnt(14)
    v_mfma_f32_16x16x32_bf16 v[32:35], v[160:163], a[96:99], v[32:35]
    buffer_load_dwordx4 a[144:147], v4, s[20:23], s54 offen offset:1024
    v_mfma_f32_16x16x32_bf16 v[64:67], v[160:163], a[100:103], v[64:67]
    ds_read_b64_tr_b16 v[192:193], v210 offset:28672
    v_mfma_f32_16x16x32_bf16 v[96:99], v[160:163], a[104:107], v[96:99]
    v_mfma_f32_16x16x32_bf16 v[128:131], v[160:163], a[108:111], v[128:131]
    ds_read_b64_tr_b16 v[194:195], v210 offset:30720
    s_waitcnt lgkmcnt(14)
    v_mfma_f32_16x16x32_bf16 v[36:39], v[164:167], a[96:99], v[36:39]
    buffer_load_dwordx4 a[148:151], v5, s[20:23], s54 offen offset:1024
    v_mfma_f32_16x16x32_bf16 v[68:71], v[164:167], a[100:103], v[68:71]
    ds_read_b64_tr_b16 v[196:197], v214 offset:28672
    v_mfma_f32_16x16x32_bf16 v[100:103], v[164:167], a[104:107], v[100:103]
    v_mfma_f32_16x16x32_bf16 v[132:135], v[164:167], a[108:111], v[132:135]
    ds_read_b64_tr_b16 v[198:199], v214 offset:30720
    s_waitcnt lgkmcnt(14)
    v_mfma_f32_16x16x32_bf16 v[40:43], v[168:171], a[96:99], v[40:43]
    buffer_load_dwordx4 a[152:155], v6, s[20:23], s54 offen offset:1024
    v_mfma_f32_16x16x32_bf16 v[72:75], v[168:171], a[100:103], v[72:75]
    ds_read_b64_tr_b16 v[200:201], v211 offset:28672
    v_mfma_f32_16x16x32_bf16 v[104:107], v[168:171], a[104:107], v[104:107]
    v_mfma_f32_16x16x32_bf16 v[136:139], v[168:171], a[108:111], v[136:139]
    ds_read_b64_tr_b16 v[202:203], v211 offset:30720
    s_waitcnt lgkmcnt(14)
    v_mfma_f32_16x16x32_bf16 v[44:47], v[172:175], a[96:99], v[44:47]
    buffer_load_dwordx4 a[156:159], v7, s[20:23], s54 offen offset:1024
    v_mfma_f32_16x16x32_bf16 v[76:79], v[172:175], a[100:103], v[76:79]
    ds_read_b64_tr_b16 v[204:205], v215 offset:28672
    v_mfma_f32_16x16x32_bf16 v[108:111], v[172:175], a[104:107], v[108:111]
    v_mfma_f32_16x16x32_bf16 v[140:143], v[172:175], a[108:111], v[140:143]
    ds_read_b64_tr_b16 v[206:207], v215 offset:30720
    s_waitcnt vmcnt(14)
    s_waitcnt lgkmcnt(14)
    v_mfma_f32_16x16x32_bf16 v[16:19], v[176:179], a[112:115], v[16:19]
    s_add_u32 m0, s52, 53248
    s_mov_b32 s57, 1490944
    v_mfma_f32_16x16x32_bf16 v[48:51], v[176:179], a[116:119], v[48:51]
    v_mfma_f32_16x16x32_bf16 v[80:83], v[176:179], a[120:123], v[80:83]
    buffer_load_dwordx4 v3, s[16:19], s57 offen lds
    v_mfma_f32_16x16x32_bf16 v[112:115], v[176:179], a[124:127], v[112:115]
    s_waitcnt lgkmcnt(12)
    v_mfma_f32_16x16x32_bf16 v[20:23], v[180:183], a[112:115], v[20:23]
    s_waitcnt vmcnt(19)
    s_barrier
    v_mfma_f32_16x16x32_bf16 v[52:55], v[180:183], a[116:119], v[52:55]
    ds_read_b64_tr_b16 v[144:145], v208 offset:32768
    v_mfma_f32_16x16x32_bf16 v[84:87], v[180:183], a[120:123], v[84:87]
    ds_read_b64_tr_b16 v[146:147], v208 offset:34816
    v_mfma_f32_16x16x32_bf16 v[116:119], v[180:183], a[124:127], v[116:119]
    s_waitcnt lgkmcnt(12)
    v_mfma_f32_16x16x32_bf16 v[24:27], v[184:187], a[112:115], v[24:27]
    s_add_u32 m0, s52, 118784
    ds_read_b64_tr_b16 v[148:149], v212 offset:32768
    v_mfma_f32_16x16x32_bf16 v[56:59], v[184:187], a[116:119], v[56:59]
    v_mfma_f32_16x16x32_bf16 v[88:91], v[184:187], a[120:123], v[88:91]
    ds_read_b64_tr_b16 v[150:151], v212 offset:34816
    v_mfma_f32_16x16x32_bf16 v[120:123], v[184:187], a[124:127], v[120:123]
    ds_read_b64_tr_b16 v[152:153], v209 offset:32768
    s_waitcnt lgkmcnt(13)
    v_mfma_f32_16x16x32_bf16 v[28:31], v[188:191], a[112:115], v[28:31]
    buffer_load_dwordx4 v3, s[24:27], s57 offen lds
    v_mfma_f32_16x16x32_bf16 v[60:63], v[188:191], a[116:119], v[60:63]
    ds_read_b64_tr_b16 v[154:155], v209 offset:34816
    v_mfma_f32_16x16x32_bf16 v[92:95], v[188:191], a[120:123], v[92:95]
    v_mfma_f32_16x16x32_bf16 v[124:127], v[188:191], a[124:127], v[124:127]
    ds_read_b64_tr_b16 v[156:157], v213 offset:32768
    s_waitcnt lgkmcnt(13)
    v_mfma_f32_16x16x32_bf16 v[32:35], v[192:195], a[112:115], v[32:35]
    buffer_load_dwordx4 a[160:163], v4, s[20:23], s54 offen offset:2048
    v_mfma_f32_16x16x32_bf16 v[64:67], v[192:195], a[116:119], v[64:67]
    ds_read_b64_tr_b16 v[158:159], v213 offset:34816
    v_mfma_f32_16x16x32_bf16 v[96:99], v[192:195], a[120:123], v[96:99]
    ds_read_b64_tr_b16 v[160:161], v210 offset:32768
    v_mfma_f32_16x16x32_bf16 v[128:131], v[192:195], a[124:127], v[128:131]
    s_waitcnt lgkmcnt(13)
    v_mfma_f32_16x16x32_bf16 v[36:39], v[196:199], a[112:115], v[36:39]
    buffer_load_dwordx4 a[164:167], v5, s[20:23], s54 offen offset:2048
    ds_read_b64_tr_b16 v[162:163], v210 offset:34816
    v_mfma_f32_16x16x32_bf16 v[68:71], v[196:199], a[116:119], v[68:71]
    v_mfma_f32_16x16x32_bf16 v[100:103], v[196:199], a[120:123], v[100:103]
    ds_read_b64_tr_b16 v[164:165], v214 offset:32768
    v_mfma_f32_16x16x32_bf16 v[132:135], v[196:199], a[124:127], v[132:135]
    s_waitcnt lgkmcnt(13)
    v_mfma_f32_16x16x32_bf16 v[40:43], v[200:203], a[112:115], v[40:43]
    buffer_load_dwordx4 a[168:171], v6, s[20:23], s54 offen offset:2048
    ds_read_b64_tr_b16 v[166:167], v214 offset:34816
    v_mfma_f32_16x16x32_bf16 v[72:75], v[200:203], a[116:119], v[72:75]
    ds_read_b64_tr_b16 v[168:169], v211 offset:32768
    v_mfma_f32_16x16x32_bf16 v[104:107], v[200:203], a[120:123], v[104:107]
    v_mfma_f32_16x16x32_bf16 v[136:139], v[200:203], a[124:127], v[136:139]
    ds_read_b64_tr_b16 v[170:171], v211 offset:34816
    s_waitcnt lgkmcnt(14)
    v_mfma_f32_16x16x32_bf16 v[44:47], v[204:207], a[112:115], v[44:47]
    buffer_load_dwordx4 a[172:175], v7, s[20:23], s54 offen offset:2048
    v_mfma_f32_16x16x32_bf16 v[76:79], v[204:207], a[116:119], v[76:79]
    ds_read_b64_tr_b16 v[172:173], v215 offset:32768
    v_mfma_f32_16x16x32_bf16 v[108:111], v[204:207], a[120:123], v[108:111]
    v_mfma_f32_16x16x32_bf16 v[140:143], v[204:207], a[124:127], v[140:143]
    ds_read_b64_tr_b16 v[174:175], v215 offset:34816
    s_waitcnt vmcnt(12)
    s_waitcnt lgkmcnt(14)
    v_mfma_f32_16x16x32_bf16 v[16:19], v[144:147], a[128:131], v[16:19]
    s_add_u32 m0, s52, 57344
    s_mov_b32 s57, 1605632
    v_mfma_f32_16x16x32_bf16 v[48:51], v[144:147], a[132:135], v[48:51]
    ds_read_b64_tr_b16 v[176:177], v208 offset:36864
    v_mfma_f32_16x16x32_bf16 v[80:83], v[144:147], a[136:139], v[80:83]
    v_mfma_f32_16x16x32_bf16 v[112:115], v[144:147], a[140:143], v[112:115]
    ds_read_b64_tr_b16 v[178:179], v208 offset:38912
    s_waitcnt lgkmcnt(14)
    v_mfma_f32_16x16x32_bf16 v[20:23], v[148:151], a[128:131], v[20:23]
    buffer_load_dwordx4 v3, s[16:19], s57 offen lds
    v_mfma_f32_16x16x32_bf16 v[52:55], v[148:151], a[132:135], v[52:55]
    ds_read_b64_tr_b16 v[180:181], v212 offset:36864
    v_mfma_f32_16x16x32_bf16 v[84:87], v[148:151], a[136:139], v[84:87]
    v_mfma_f32_16x16x32_bf16 v[116:119], v[148:151], a[140:143], v[116:119]
    ds_read_b64_tr_b16 v[182:183], v212 offset:38912
    s_waitcnt lgkmcnt(14)
    v_mfma_f32_16x16x32_bf16 v[24:27], v[152:155], a[128:131], v[24:27]
    s_add_u32 m0, s52, 122880
    v_mfma_f32_16x16x32_bf16 v[56:59], v[152:155], a[132:135], v[56:59]
    ds_read_b64_tr_b16 v[184:185], v209 offset:36864
    v_mfma_f32_16x16x32_bf16 v[88:91], v[152:155], a[136:139], v[88:91]
    v_mfma_f32_16x16x32_bf16 v[120:123], v[152:155], a[140:143], v[120:123]
    ds_read_b64_tr_b16 v[186:187], v209 offset:38912
    s_waitcnt lgkmcnt(14)
    v_mfma_f32_16x16x32_bf16 v[28:31], v[156:159], a[128:131], v[28:31]
    buffer_load_dwordx4 v3, s[24:27], s57 offen lds
    v_mfma_f32_16x16x32_bf16 v[60:63], v[156:159], a[132:135], v[60:63]
    ds_read_b64_tr_b16 v[188:189], v213 offset:36864
    v_mfma_f32_16x16x32_bf16 v[92:95], v[156:159], a[136:139], v[92:95]
    v_mfma_f32_16x16x32_bf16 v[124:127], v[156:159], a[140:143], v[124:127]
    ds_read_b64_tr_b16 v[190:191], v213 offset:38912
    s_waitcnt lgkmcnt(14)
    v_mfma_f32_16x16x32_bf16 v[32:35], v[160:163], a[128:131], v[32:35]
    buffer_load_dwordx4 a[176:179], v4, s[20:23], s54 offen offset:3072
    v_mfma_f32_16x16x32_bf16 v[64:67], v[160:163], a[132:135], v[64:67]
    ds_read_b64_tr_b16 v[192:193], v210 offset:36864
    v_mfma_f32_16x16x32_bf16 v[96:99], v[160:163], a[136:139], v[96:99]
    v_mfma_f32_16x16x32_bf16 v[128:131], v[160:163], a[140:143], v[128:131]
    ds_read_b64_tr_b16 v[194:195], v210 offset:38912
    s_waitcnt lgkmcnt(14)
    v_mfma_f32_16x16x32_bf16 v[36:39], v[164:167], a[128:131], v[36:39]
    buffer_load_dwordx4 a[180:183], v5, s[20:23], s54 offen offset:3072
    v_mfma_f32_16x16x32_bf16 v[68:71], v[164:167], a[132:135], v[68:71]
    ds_read_b64_tr_b16 v[196:197], v214 offset:36864
    v_mfma_f32_16x16x32_bf16 v[100:103], v[164:167], a[136:139], v[100:103]
    v_mfma_f32_16x16x32_bf16 v[132:135], v[164:167], a[140:143], v[132:135]
    ds_read_b64_tr_b16 v[198:199], v214 offset:38912
    s_waitcnt lgkmcnt(14)
    v_mfma_f32_16x16x32_bf16 v[40:43], v[168:171], a[128:131], v[40:43]
    buffer_load_dwordx4 a[184:187], v6, s[20:23], s54 offen offset:3072
    v_mfma_f32_16x16x32_bf16 v[72:75], v[168:171], a[132:135], v[72:75]
    ds_read_b64_tr_b16 v[200:201], v211 offset:36864
    v_mfma_f32_16x16x32_bf16 v[104:107], v[168:171], a[136:139], v[104:107]
    v_mfma_f32_16x16x32_bf16 v[136:139], v[168:171], a[140:143], v[136:139]
    ds_read_b64_tr_b16 v[202:203], v211 offset:38912
    s_waitcnt lgkmcnt(14)
    v_mfma_f32_16x16x32_bf16 v[44:47], v[172:175], a[128:131], v[44:47]
    buffer_load_dwordx4 a[188:191], v7, s[20:23], s54 offen offset:3072
    v_mfma_f32_16x16x32_bf16 v[76:79], v[172:175], a[132:135], v[76:79]
    ds_read_b64_tr_b16 v[204:205], v215 offset:36864
    v_mfma_f32_16x16x32_bf16 v[108:111], v[172:175], a[136:139], v[108:111]
    v_mfma_f32_16x16x32_bf16 v[140:143], v[172:175], a[140:143], v[140:143]
    ds_read_b64_tr_b16 v[206:207], v215 offset:38912
    s_waitcnt vmcnt(12)
    s_waitcnt lgkmcnt(14)
    v_mfma_f32_16x16x32_bf16 v[16:19], v[176:179], a[144:147], v[16:19]
    s_add_u32 m0, s52, 61440
    s_mov_b32 s57, 1720320
    v_mfma_f32_16x16x32_bf16 v[48:51], v[176:179], a[148:151], v[48:51]
    v_mfma_f32_16x16x32_bf16 v[80:83], v[176:179], a[152:155], v[80:83]
    buffer_load_dwordx4 v3, s[16:19], s57 offen lds
    v_mfma_f32_16x16x32_bf16 v[112:115], v[176:179], a[156:159], v[112:115]
    s_waitcnt lgkmcnt(12)
    v_mfma_f32_16x16x32_bf16 v[20:23], v[180:183], a[144:147], v[20:23]
    s_waitcnt vmcnt(23)
    s_barrier
    v_mfma_f32_16x16x32_bf16 v[52:55], v[180:183], a[148:151], v[52:55]
    ds_read_b64_tr_b16 v[144:145], v208 offset:40960
    v_mfma_f32_16x16x32_bf16 v[84:87], v[180:183], a[152:155], v[84:87]
    ds_read_b64_tr_b16 v[146:147], v208 offset:43008
    v_mfma_f32_16x16x32_bf16 v[116:119], v[180:183], a[156:159], v[116:119]
    s_waitcnt lgkmcnt(12)
    v_mfma_f32_16x16x32_bf16 v[24:27], v[184:187], a[144:147], v[24:27]
    s_add_u32 m0, s52, 126976
    ds_read_b64_tr_b16 v[148:149], v212 offset:40960
    v_mfma_f32_16x16x32_bf16 v[56:59], v[184:187], a[148:151], v[56:59]
    v_mfma_f32_16x16x32_bf16 v[88:91], v[184:187], a[152:155], v[88:91]
    ds_read_b64_tr_b16 v[150:151], v212 offset:43008
    v_mfma_f32_16x16x32_bf16 v[120:123], v[184:187], a[156:159], v[120:123]
    ds_read_b64_tr_b16 v[152:153], v209 offset:40960
    s_waitcnt lgkmcnt(13)
    v_mfma_f32_16x16x32_bf16 v[28:31], v[188:191], a[144:147], v[28:31]
    buffer_load_dwordx4 v3, s[24:27], s57 offen lds
    v_mfma_f32_16x16x32_bf16 v[60:63], v[188:191], a[148:151], v[60:63]
    ds_read_b64_tr_b16 v[154:155], v209 offset:43008
    v_mfma_f32_16x16x32_bf16 v[92:95], v[188:191], a[152:155], v[92:95]
    v_mfma_f32_16x16x32_bf16 v[124:127], v[188:191], a[156:159], v[124:127]
    ds_read_b64_tr_b16 v[156:157], v213 offset:40960
    s_waitcnt lgkmcnt(13)
    v_mfma_f32_16x16x32_bf16 v[32:35], v[192:195], a[144:147], v[32:35]
    buffer_load_dwordx4 a[192:195], v4, s[20:23], s55 offen offset:0
    v_mfma_f32_16x16x32_bf16 v[64:67], v[192:195], a[148:151], v[64:67]
    ds_read_b64_tr_b16 v[158:159], v213 offset:43008
    v_mfma_f32_16x16x32_bf16 v[96:99], v[192:195], a[152:155], v[96:99]
    ds_read_b64_tr_b16 v[160:161], v210 offset:40960
    v_mfma_f32_16x16x32_bf16 v[128:131], v[192:195], a[156:159], v[128:131]
    s_waitcnt lgkmcnt(13)
    v_mfma_f32_16x16x32_bf16 v[36:39], v[196:199], a[144:147], v[36:39]
    buffer_load_dwordx4 a[196:199], v5, s[20:23], s55 offen offset:0
    ds_read_b64_tr_b16 v[162:163], v210 offset:43008
    v_mfma_f32_16x16x32_bf16 v[68:71], v[196:199], a[148:151], v[68:71]
    v_mfma_f32_16x16x32_bf16 v[100:103], v[196:199], a[152:155], v[100:103]
    ds_read_b64_tr_b16 v[164:165], v214 offset:40960
    v_mfma_f32_16x16x32_bf16 v[132:135], v[196:199], a[156:159], v[132:135]
    s_waitcnt lgkmcnt(13)
    v_mfma_f32_16x16x32_bf16 v[40:43], v[200:203], a[144:147], v[40:43]
    buffer_load_dwordx4 a[200:203], v6, s[20:23], s55 offen offset:0
    ds_read_b64_tr_b16 v[166:167], v214 offset:43008
    v_mfma_f32_16x16x32_bf16 v[72:75], v[200:203], a[148:151], v[72:75]
    ds_read_b64_tr_b16 v[168:169], v211 offset:40960
    v_mfma_f32_16x16x32_bf16 v[104:107], v[200:203], a[152:155], v[104:107]
    v_mfma_f32_16x16x32_bf16 v[136:139], v[200:203], a[156:159], v[136:139]
    ds_read_b64_tr_b16 v[170:171], v211 offset:43008
    s_waitcnt lgkmcnt(14)
    v_mfma_f32_16x16x32_bf16 v[44:47], v[204:207], a[144:147], v[44:47]
    buffer_load_dwordx4 a[204:207], v7, s[20:23], s55 offen offset:0
    v_mfma_f32_16x16x32_bf16 v[76:79], v[204:207], a[148:151], v[76:79]
    ds_read_b64_tr_b16 v[172:173], v215 offset:40960
    v_mfma_f32_16x16x32_bf16 v[108:111], v[204:207], a[152:155], v[108:111]
    v_mfma_f32_16x16x32_bf16 v[140:143], v[204:207], a[156:159], v[140:143]
    ds_read_b64_tr_b16 v[174:175], v215 offset:43008
    s_waitcnt vmcnt(12)
    s_waitcnt lgkmcnt(14)
    v_mfma_f32_16x16x32_bf16 v[16:19], v[144:147], a[160:163], v[16:19]
    buffer_load_dwordx4 a[208:211], v4, s[20:23], s55 offen offset:1024
    v_mfma_f32_16x16x32_bf16 v[48:51], v[144:147], a[164:167], v[48:51]
    ds_read_b64_tr_b16 v[176:177], v208 offset:45056
    v_mfma_f32_16x16x32_bf16 v[80:83], v[144:147], a[168:171], v[80:83]
    v_mfma_f32_16x16x32_bf16 v[112:115], v[144:147], a[172:175], v[112:115]
    ds_read_b64_tr_b16 v[178:179], v208 offset:47104
    s_waitcnt lgkmcnt(14)
    v_mfma_f32_16x16x32_bf16 v[20:23], v[148:151], a[160:163], v[20:23]
    v_mfma_f32_16x16x32_bf16 v[52:55], v[148:151], a[164:167], v[52:55]
    ds_read_b64_tr_b16 v[180:181], v212 offset:45056
    v_mfma_f32_16x16x32_bf16 v[84:87], v[148:151], a[168:171], v[84:87]
    v_mfma_f32_16x16x32_bf16 v[116:119], v[148:151], a[172:175], v[116:119]
    ds_read_b64_tr_b16 v[182:183], v212 offset:47104
    s_waitcnt lgkmcnt(14)
    v_mfma_f32_16x16x32_bf16 v[24:27], v[152:155], a[160:163], v[24:27]
    buffer_load_dwordx4 a[212:215], v5, s[20:23], s55 offen offset:1024
    v_mfma_f32_16x16x32_bf16 v[56:59], v[152:155], a[164:167], v[56:59]
    ds_read_b64_tr_b16 v[184:185], v209 offset:45056
    v_mfma_f32_16x16x32_bf16 v[88:91], v[152:155], a[168:171], v[88:91]
    v_mfma_f32_16x16x32_bf16 v[120:123], v[152:155], a[172:175], v[120:123]
    ds_read_b64_tr_b16 v[186:187], v209 offset:47104
    s_waitcnt lgkmcnt(14)
    v_mfma_f32_16x16x32_bf16 v[28:31], v[156:159], a[160:163], v[28:31]
    v_mfma_f32_16x16x32_bf16 v[60:63], v[156:159], a[164:167], v[60:63]
    ds_read_b64_tr_b16 v[188:189], v213 offset:45056
    v_mfma_f32_16x16x32_bf16 v[92:95], v[156:159], a[168:171], v[92:95]
    v_mfma_f32_16x16x32_bf16 v[124:127], v[156:159], a[172:175], v[124:127]
    ds_read_b64_tr_b16 v[190:191], v213 offset:47104
    s_waitcnt lgkmcnt(14)
    v_mfma_f32_16x16x32_bf16 v[32:35], v[160:163], a[160:163], v[32:35]
    buffer_load_dwordx4 a[216:219], v6, s[20:23], s55 offen offset:1024
    v_mfma_f32_16x16x32_bf16 v[64:67], v[160:163], a[164:167], v[64:67]
    ds_read_b64_tr_b16 v[192:193], v210 offset:45056
    v_mfma_f32_16x16x32_bf16 v[96:99], v[160:163], a[168:171], v[96:99]
    v_mfma_f32_16x16x32_bf16 v[128:131], v[160:163], a[172:175], v[128:131]
    ds_read_b64_tr_b16 v[194:195], v210 offset:47104
    s_waitcnt lgkmcnt(14)
    v_mfma_f32_16x16x32_bf16 v[36:39], v[164:167], a[160:163], v[36:39]
    v_mfma_f32_16x16x32_bf16 v[68:71], v[164:167], a[164:167], v[68:71]
    ds_read_b64_tr_b16 v[196:197], v214 offset:45056
    v_mfma_f32_16x16x32_bf16 v[100:103], v[164:167], a[168:171], v[100:103]
    v_mfma_f32_16x16x32_bf16 v[132:135], v[164:167], a[172:175], v[132:135]
    ds_read_b64_tr_b16 v[198:199], v214 offset:47104
    s_waitcnt lgkmcnt(14)
    v_mfma_f32_16x16x32_bf16 v[40:43], v[168:171], a[160:163], v[40:43]
    buffer_load_dwordx4 a[220:223], v7, s[20:23], s55 offen offset:1024
    v_mfma_f32_16x16x32_bf16 v[72:75], v[168:171], a[164:167], v[72:75]
    ds_read_b64_tr_b16 v[200:201], v211 offset:45056
    v_mfma_f32_16x16x32_bf16 v[104:107], v[168:171], a[168:171], v[104:107]
    v_mfma_f32_16x16x32_bf16 v[136:139], v[168:171], a[172:175], v[136:139]
    ds_read_b64_tr_b16 v[202:203], v211 offset:47104
    s_waitcnt lgkmcnt(14)
    v_mfma_f32_16x16x32_bf16 v[44:47], v[172:175], a[160:163], v[44:47]
    v_mfma_f32_16x16x32_bf16 v[76:79], v[172:175], a[164:167], v[76:79]
    ds_read_b64_tr_b16 v[204:205], v215 offset:45056
    v_mfma_f32_16x16x32_bf16 v[108:111], v[172:175], a[168:171], v[108:111]
    v_mfma_f32_16x16x32_bf16 v[140:143], v[172:175], a[172:175], v[140:143]
    ds_read_b64_tr_b16 v[206:207], v215 offset:47104
    s_waitcnt vmcnt(10)
    s_waitcnt lgkmcnt(14)
    v_mfma_f32_16x16x32_bf16 v[16:19], v[176:179], a[176:179], v[16:19]
    buffer_load_dwordx4 a[224:227], v4, s[20:23], s55 offen offset:2048
    v_mfma_f32_16x16x32_bf16 v[48:51], v[176:179], a[180:183], v[48:51]
    v_mfma_f32_16x16x32_bf16 v[80:83], v[176:179], a[184:187], v[80:83]
    v_mfma_f32_16x16x32_bf16 v[112:115], v[176:179], a[188:191], v[112:115]
    s_waitcnt lgkmcnt(12)
    v_mfma_f32_16x16x32_bf16 v[20:23], v[180:183], a[176:179], v[20:23]
    s_waitcnt vmcnt(9)
    s_barrier
    v_mfma_f32_16x16x32_bf16 v[52:55], v[180:183], a[180:183], v[52:55]
    ds_read_b64_tr_b16 v[144:145], v208 offset:49152
    v_mfma_f32_16x16x32_bf16 v[84:87], v[180:183], a[184:187], v[84:87]
    ds_read_b64_tr_b16 v[146:147], v208 offset:51200
    v_mfma_f32_16x16x32_bf16 v[116:119], v[180:183], a[188:191], v[116:119]
    s_waitcnt lgkmcnt(12)
    v_mfma_f32_16x16x32_bf16 v[24:27], v[184:187], a[176:179], v[24:27]
    buffer_load_dwordx4 a[228:231], v5, s[20:23], s55 offen offset:2048
    ds_read_b64_tr_b16 v[148:149], v212 offset:49152
    v_mfma_f32_16x16x32_bf16 v[56:59], v[184:187], a[180:183], v[56:59]
    v_mfma_f32_16x16x32_bf16 v[88:91], v[184:187], a[184:187], v[88:91]
    ds_read_b64_tr_b16 v[150:151], v212 offset:51200
    v_mfma_f32_16x16x32_bf16 v[120:123], v[184:187], a[188:191], v[120:123]
    ds_read_b64_tr_b16 v[152:153], v209 offset:49152
    s_waitcnt lgkmcnt(13)
    v_mfma_f32_16x16x32_bf16 v[28:31], v[188:191], a[176:179], v[28:31]
    v_mfma_f32_16x16x32_bf16 v[60:63], v[188:191], a[180:183], v[60:63]
    ds_read_b64_tr_b16 v[154:155], v209 offset:51200
    v_mfma_f32_16x16x32_bf16 v[92:95], v[188:191], a[184:187], v[92:95]
    buffer_load_dwordx4 a[232:235], v6, s[20:23], s55 offen offset:2048
    v_mfma_f32_16x16x32_bf16 v[124:127], v[188:191], a[188:191], v[124:127]
    ds_read_b64_tr_b16 v[156:157], v213 offset:49152
    s_waitcnt lgkmcnt(13)
    v_mfma_f32_16x16x32_bf16 v[32:35], v[192:195], a[176:179], v[32:35]
    v_mfma_f32_16x16x32_bf16 v[64:67], v[192:195], a[180:183], v[64:67]
    ds_read_b64_tr_b16 v[158:159], v213 offset:51200
    v_mfma_f32_16x16x32_bf16 v[96:99], v[192:195], a[184:187], v[96:99]
    ds_read_b64_tr_b16 v[160:161], v210 offset:49152
    v_mfma_f32_16x16x32_bf16 v[128:131], v[192:195], a[188:191], v[128:131]
    s_waitcnt lgkmcnt(13)
    v_mfma_f32_16x16x32_bf16 v[36:39], v[196:199], a[176:179], v[36:39]
    buffer_load_dwordx4 a[236:239], v7, s[20:23], s55 offen offset:2048
    ds_read_b64_tr_b16 v[162:163], v210 offset:51200
    v_mfma_f32_16x16x32_bf16 v[68:71], v[196:199], a[180:183], v[68:71]
    v_mfma_f32_16x16x32_bf16 v[100:103], v[196:199], a[184:187], v[100:103]
    ds_read_b64_tr_b16 v[164:165], v214 offset:49152
    v_mfma_f32_16x16x32_bf16 v[132:135], v[196:199], a[188:191], v[132:135]
    s_waitcnt lgkmcnt(13)
    v_mfma_f32_16x16x32_bf16 v[40:43], v[200:203], a[176:179], v[40:43]
    ds_read_b64_tr_b16 v[166:167], v214 offset:51200
    v_mfma_f32_16x16x32_bf16 v[72:75], v[200:203], a[180:183], v[72:75]
    ds_read_b64_tr_b16 v[168:169], v211 offset:49152
    v_mfma_f32_16x16x32_bf16 v[104:107], v[200:203], a[184:187], v[104:107]
    global_load_dword v12, v11, s[14:15] sc1
    v_mfma_f32_16x16x32_bf16 v[136:139], v[200:203], a[188:191], v[136:139]
    ds_read_b64_tr_b16 v[170:171], v211 offset:51200
    s_waitcnt lgkmcnt(14)
    v_mfma_f32_16x16x32_bf16 v[44:47], v[204:207], a[176:179], v[44:47]
    v_mfma_f32_16x16x32_bf16 v[76:79], v[204:207], a[180:183], v[76:79]
    ds_read_b64_tr_b16 v[172:173], v215 offset:49152
    v_mfma_f32_16x16x32_bf16 v[108:111], v[204:207], a[184:187], v[108:111]
    v_mfma_f32_16x16x32_bf16 v[140:143], v[204:207], a[188:191], v[140:143]
    ds_read_b64_tr_b16 v[174:175], v215 offset:51200
    s_waitcnt vmcnt(9)
    s_waitcnt vmcnt(0)
    v_readfirstlane_b32 s50, v12
    s_mov_b32 s51, 0
    s_cmp_ge_u32 s50, 32
    s_cbranch_scc1 g_ready
g_poll:
    global_load_dword v12, v11, s[14:15] sc1
    s_add_u32 s51, s51, 1
    s_waitcnt vmcnt(0)
    v_readfirstlane_b32 s50, v12
    s_nop 0
    s_cmp_ge_u32 s50, 32
    s_cbranch_scc1 g_ready
    s_cmp_lt_u32 s51, 200000
    s_cbranch_scc0 g_ready
    s_sleep 2
    s_branch g_poll
g_ready:
    s_waitcnt lgkmcnt(14)
    v_mfma_f32_16x16x32_bf16 v[16:19], v[144:147], a[192:195], v[16:19]
    buffer_load_dwordx4 a[240:243], v4, s[20:23], s55 offen offset:3072
    v_mfma_f32_16x16x32_bf16 v[48:51], v[144:147], a[196:199], v[48:51]
    ds_read_b64_tr_b16 v[176:177], v208 offset:53248
    v_mfma_f32_16x16x32_bf16 v[80:83], v[144:147], a[200:203], v[80:83]
    v_mfma_f32_16x16x32_bf16 v[112:115], v[144:147], a[204:207], v[112:115]
    ds_read_b64_tr_b16 v[178:179], v208 offset:55296
    s_waitcnt lgkmcnt(14)
    v_mfma_f32_16x16x32_bf16 v[20:23], v[148:151], a[192:195], v[20:23]
    buffer_load_dwordx4 a[244:247], v5, s[20:23], s55 offen offset:3072
    v_mfma_f32_16x16x32_bf16 v[52:55], v[148:151], a[196:199], v[52:55]
    ds_read_b64_tr_b16 v[180:181], v212 offset:53248
    v_mfma_f32_16x16x32_bf16 v[84:87], v[148:151], a[200:203], v[84:87]
    v_mfma_f32_16x16x32_bf16 v[116:119], v[148:151], a[204:207], v[116:119]
    ds_read_b64_tr_b16 v[182:183], v212 offset:55296
    s_waitcnt lgkmcnt(14)
    v_mfma_f32_16x16x32_bf16 v[24:27], v[152:155], a[192:195], v[24:27]
    buffer_load_dwordx4 a[248:251], v6, s[20:23], s55 offen offset:3072
    v_mfma_f32_16x16x32_bf16 v[56:59], v[152:155], a[196:199], v[56:59]
    ds_read_b64_tr_b16 v[184:185], v209 offset:53248
    v_mfma_f32_16x16x32_bf16 v[88:91], v[152:155], a[200:203], v[88:91]
    v_mfma_f32_16x16x32_bf16 v[120:123], v[152:155], a[204:207], v[120:123]
    ds_read_b64_tr_b16 v[186:187], v209 offset:55296
    s_waitcnt lgkmcnt(14)
    v_mfma_f32_16x16x32_bf16 v[28:31], v[156:159], a[192:195], v[28:31]
    buffer_load_dwordx4 a[252:255], v7, s[20:23], s55 offen offset:3072
    v_mfma_f32_16x16x32_bf16 v[60:63], v[156:159], a[196:199], v[60:63]
    ds_read_b64_tr_b16 v[188:189], v213 offset:53248
    v_mfma_f32_16x16x32_bf16 v[92:95], v[156:159], a[200:203], v[92:95]
    v_mfma_f32_16x16x32_bf16 v[124:127], v[156:159], a[204:207], v[124:127]
    ds_read_b64_tr_b16 v[190:191], v213 offset:55296
    s_waitcnt lgkmcnt(14)
    v_mfma_f32_16x16x32_bf16 v[32:35], v[160:163], a[192:195], v[32:35]
    buffer_load_dwordx4 v[216:219], v8, s[28:31], 0 offen offset:0 sc1
    v_mfma_f32_16x16x32_bf16 v[64:67], v[160:163], a[196:199], v[64:67]
    ds_read_b64_tr_b16 v[192:193], v210 offset:53248
    v_mfma_f32_16x16x32_bf16 v[96:99], v[160:163], a[200:203], v[96:99]
    v_mfma_f32_16x16x32_bf16 v[128:131], v[160:163], a[204:207], v[128:131]
    ds_read_b64_tr_b16 v[194:195], v210 offset:55296
    s_waitcnt lgkmcnt(14)
    v_mfma_f32_16x16x32_bf16 v[36:39], v[164:167], a[192:195], v[36:39]
    buffer_load_dwordx4 v[220:223], v9, s[28:31], 0 offen offset:0 sc1
    v_mfma_f32_16x16x32_bf16 v[68:71], v[164:167], a[196:199], v[68:71]
    ds_read_b64_tr_b16 v[196:197], v214 offset:53248
    v_mfma_f32_16x16x32_bf16 v[100:103], v[164:167], a[200:203], v[100:103]
    v_mfma_f32_16x16x32_bf16 v[132:135], v[164:167], a[204:207], v[132:135]
    ds_read_b64_tr_b16 v[198:199], v214 offset:55296
    s_waitcnt lgkmcnt(14)
    v_mfma_f32_16x16x32_bf16 v[40:43], v[168:171], a[192:195], v[40:43]
    buffer_load_dwordx4 v[224:227], v8, s[28:31], 0 offen offset:64 sc1
    v_mfma_f32_16x16x32_bf16 v[72:75], v[168:171], a[196:199], v[72:75]
    ds_read_b64_tr_b16 v[200:201], v211 offset:53248
    v_mfma_f32_16x16x32_bf16 v[104:107], v[168:171], a[200:203], v[104:107]
    v_mfma_f32_16x16x32_bf16 v[136:139], v[168:171], a[204:207], v[136:139]
    ds_read_b64_tr_b16 v[202:203], v211 offset:55296
    s_waitcnt lgkmcnt(14)
    v_mfma_f32_16x16x32_bf16 v[44:47], v[172:175], a[192:195], v[44:47]
    buffer_load_dwordx4 v[228:231], v9, s[28:31], 0 offen offset:64 sc1
    v_mfma_f32_16x16x32_bf16 v[76:79], v[172:175], a[196:199], v[76:79]
    ds_read_b64_tr_b16 v[204:205], v215 offset:53248
    v_mfma_f32_16x16x32_bf16 v[108:111], v[172:175], a[200:203], v[108:111]
    v_mfma_f32_16x16x32_bf16 v[140:143], v[172:175], a[204:207], v[140:143]
    ds_read_b64_tr_b16 v[206:207], v215 offset:55296
    s_waitcnt vmcnt(13)
    s_waitcnt lgkmcnt(14)
    v_mfma_f32_16x16x32_bf16 v[16:19], v[176:179], a[208:211], v[16:19]
    buffer_load_dwordx4 v[232:235], v8, s[28:31], 0 offen offset:128 sc1
    v_mfma_f32_16x16x32_bf16 v[48:51], v[176:179], a[212:215], v[48:51]
    ds_read_b64_tr_b16 v[144:145], v208 offset:57344
    v_mfma_f32_16x16x32_bf16 v[80:83], v[176:179], a[216:219], v[80:83]
    buffer_load_dwordx4 v[236:239], v9, s[28:31], 0 offen offset:128 sc1
    v_mfma_f32_16x16x32_bf16 v[112:115], v[176:179], a[220:223], v[112:115]
    ds_read_b64_tr_b16 v[146:147], v208 offset:59392
    s_waitcnt lgkmcnt(14)
    v_mfma_f32_16x16x32_bf16 v[20:23], v[180:183], a[208:211], v[20:23]
    buffer_load_dwordx4 v[240:243], v8, s[28:31], 0 offen offset:192 sc1
    v_mfma_f32_16x16x32_bf16 v[52:55], v[180:183], a[212:215], v[52:55]
    ds_read_b64_tr_b16 v[148:149], v212 offset:57344
    v_mfma_f32_16x16x32_bf16 v[84:87], v[180:183], a[216:219], v[84:87]
    v_mfma_f32_16x16x32_bf16 v[116:119], v[180:183], a[220:223], v[116:119]
    ds_read_b64_tr_b16 v[150:151], v212 offset:59392
    s_waitcnt lgkmcnt(14)
    v_mfma_f32_16x16x32_bf16 v[24:27], v[184:187], a[208:211], v[24:27]
    buffer_load_dwordx4 v[244:247], v9, s[28:31], 0 offen offset:192 sc1
    v_mfma_f32_16x16x32_bf16 v[56:59], v[184:187], a[212:215], v[56:59]
    ds_read_b64_tr_b16 v[152:153], v209 offset:57344
    v_mfma_f32_16x16x32_bf16 v[88:91], v[184:187], a[216:219], v[88:91]
    buffer_load_dwordx2 v[248:249], v10, s[36:39], 0 offen offset:0 sc1
    v_mfma_f32_16x16x32_bf16 v[120:123], v[184:187], a[220:223], v[120:123]
    ds_read_b64_tr_b16 v[154:155], v209 offset:59392
    s_waitcnt lgkmcnt(14)
    v_mfma_f32_16x16x32_bf16 v[28:31], v[188:191], a[208:211], v[28:31]
    buffer_load_dwordx2 v[250:251], v10, s[36:39], 0 offen offset:128 sc1
    v_mfma_f32_16x16x32_bf16 v[60:63], v[188:191], a[212:215], v[60:63]
    ds_read_b64_tr_b16 v[156:157], v213 offset:57344
    v_mfma_f32_16x16x32_bf16 v[92:95], v[188:191], a[216:219], v[92:95]
    v_mfma_f32_16x16x32_bf16 v[124:127], v[188:191], a[220:223], v[124:127]
    ds_read_b64_tr_b16 v[158:159], v213 offset:59392
    s_waitcnt lgkmcnt(14)
    v_mfma_f32_16x16x32_bf16 v[32:35], v[192:195], a[208:211], v[32:35]
    buffer_load_dwordx2 v[252:253], v10, s[36:39], 0 offen offset:256 sc1
    v_mfma_f32_16x16x32_bf16 v[64:67], v[192:195], a[212:215], v[64:67]
    ds_read_b64_tr_b16 v[160:161], v210 offset:57344
    v_mfma_f32_16x16x32_bf16 v[96:99], v[192:195], a[216:219], v[96:99]
    buffer_load_dwordx2 v[254:255], v10, s[36:39], 0 offen offset:384 sc1
    v_mfma_f32_16x16x32_bf16 v[128:131], v[192:195], a[220:223], v[128:131]
    ds_read_b64_tr_b16 v[162:163], v210 offset:59392
    s_waitcnt lgkmcnt(14)
    v_mfma_f32_16x16x32_bf16 v[36:39], v[196:199], a[208:211], v[36:39]
    s_mov_b32 s57, 0
    buffer_load_dwordx4 a[0:3], v2, s[72:75], s57 offen offset:0
    v_mfma_f32_16x16x32_bf16 v[68:71], v[196:199], a[212:215], v[68:71]
    ds_read_b64_tr_b16 v[164:165], v214 offset:57344
    v_mfma_f32_16x16x32_bf16 v[100:103], v[196:199], a[216:219], v[100:103]
    v_mfma_f32_16x16x32_bf16 v[132:135], v[196:199], a[220:223], v[132:135]
    ds_read_b64_tr_b16 v[166:167], v214 offset:59392
    s_waitcnt lgkmcnt(14)
    v_mfma_f32_16x16x32_bf16 v[40:43], v[200:203], a[208:211], v[40:43]
    buffer_load_dwordx4 a[4:7], v2, s[72:75], s57 offen offset:1024
    v_mfma_f32_16x16x32_bf16 v[72:75], v[200:203], a[212:215], v[72:75]
    ds_read_b64_tr_b16 v[168:169], v211 offset:57344
    v_mfma_f32_16x16x32_bf16 v[104:107], v[200:203], a[216:219], v[104:107]
    buffer_load_dwordx4 a[8:11], v2, s[72:75], s57 offen offset:2048
    v_mfma_f32_16x16x32_bf16 v[136:139], v[200:203], a[220:223], v[136:139]
    ds_read_b64_tr_b16 v[170:171], v211 offset:59392
    s_waitcnt lgkmcnt(14)
    v_mfma_f32_16x16x32_bf16 v[44:47], v[204:207], a[208:211], v[44:47]
    buffer_load_dwordx4 a[12:15], v2, s[72:75], s57 offen offset:3072
    v_mfma_f32_16x16x32_bf16 v[76:79], v[204:207], a[212:215], v[76:79]
    ds_read_b64_tr_b16 v[172:173], v215 offset:57344
    v_mfma_f32_16x16x32_bf16 v[108:111], v[204:207], a[216:219], v[108:111]
    v_mfma_f32_16x16x32_bf16 v[140:143], v[204:207], a[220:223], v[140:143]
    ds_read_b64_tr_b16 v[174:175], v215 offset:59392
    s_waitcnt vmcnt(21)
    s_waitcnt lgkmcnt(14)
    v_mfma_f32_16x16x32_bf16 v[16:19], v[144:147], a[224:227], v[16:19]
    s_mov_b32 s57, 4096
    buffer_load_dwordx4 a[16:19], v2, s[72:75], s57 offen offset:0
    v_mfma_f32_16x16x32_bf16 v[48:51], v[144:147], a[228:231], v[48:51]
    ds_read_b64_tr_b16 v[176:177], v208 offset:61440
    v_mfma_f32_16x16x32_bf16 v[80:83], v[144:147], a[232:235], v[80:83]
    v_mfma_f32_16x16x32_bf16 v[112:115], v[144:147], a[236:239], v[112:115]
    ds_read_b64_tr_b16 v[178:179], v208 offset:63488
    s_waitcnt lgkmcnt(14)
    v_mfma_f32_16x16x32_bf16 v[20:23], v[148:151], a[224:227], v[20:23]
    v_mfma_f32_16x16x32_bf16 v[52:55], v[148:151], a[228:231], v[52:55]
    ds_read_b64_tr_b16 v[180:181], v212 offset:61440
    v_mfma_f32_16x16x32_bf16 v[84:87], v[148:151], a[232:235], v[84:87]
    v_mfma_f32_16x16x32_bf16 v[116:119], v[148:151], a[236:239], v[116:119]
    ds_read_b64_tr_b16 v[182:183], v212 offset:63488
    s_waitcnt lgkmcnt(14)
    v_mfma_f32_16x16x32_bf16 v[24:27], v[152:155], a[224:227], v[24:27]
    buffer_load_dwordx4 a[20:23], v2, s[72:75], s57 offen offset:1024
    v_mfma_f32_16x16x32_bf16 v[56:59], v[152:155], a[228:231], v[56:59]
    ds_read_b64_tr_b16 v[184:185], v209 offset:61440
    v_mfma_f32_16x16x32_bf16 v[88:91], v[152:155], a[232:235], v[88:91]
    v_mfma_f32_16x16x32_bf16 v[120:123], v[152:155], a[236:239], v[120:123]
    ds_read_b64_tr_b16 v[186:187], v209 offset:63488
    s_waitcnt lgkmcnt(14)
    v_mfma_f32_16x16x32_bf16 v[28:31], v[156:159], a[224:227], v[28:31]
    v_mfma_f32_16x16x32_bf16 v[60:63], v[156:159], a[228:231], v[60:63]
    ds_read_b64_tr_b16 v[188:189], v213 offset:61440
    v_mfma_f32_16x16x32_bf16 v[92:95], v[156:159], a[232:235], v[92:95]
    v_mfma_f32_16x16x32_bf16 v[124:127], v[156:159], a[236:239], v[124:127]
    ds_read_b64_tr_b16 v[190:191], v213 offset:63488
    s_waitcnt lgkmcnt(14)
    v_mfma_f32_16x16x32_bf16 v[32:35], v[160:163], a[224:227], v[32:35]
    buffer_load_dwordx4 a[24:27], v2, s[72:75], s57 offen offset:2048
    v_mfma_f32_16x16x32_bf16 v[64:67], v[160:163], a[228:231], v[64:67]
    ds_read_b64_tr_b16 v[192:193], v210 offset:61440
    v_mfma_f32_16x16x32_bf16 v[96:99], v[160:163], a[232:235], v[96:99]
    v_mfma_f32_16x16x32_bf16 v[128:131], v[160:163], a[236:239], v[128:131]
    ds_read_b64_tr_b16 v[194:195], v210 offset:63488
    s_waitcnt lgkmcnt(14)
    v_mfma_f32_16x16x32_bf16 v[36:39], v[164:167], a[224:227], v[36:39]
    v_mfma_f32_16x16x32_bf16 v[68:71], v[164:167], a[228:231], v[68:71]
    ds_read_b64_tr_b16 v[196:197], v214 offset:61440
    v_mfma_f32_16x16x32_bf16 v[100:103], v[164:167], a[232:235], v[100:103]
    v_mfma_f32_16x16x32_bf16 v[132:135], v[164:167], a[236:239], v[132:135]
    ds_read_b64_tr_b16 v[198:199], v214 offset:63488
    s_waitcnt lgkmcnt(14)
    v_mfma_f32_16x16x32_bf16 v[40:43], v[168:171], a[224:227], v[40:43]
    buffer_load_dwordx4 a[28:31], v2, s[72:75], s57 offen offset:3072
    v_mfma_f32_16x16x32_bf16 v[72:75], v[168:171], a[228:231], v[72:75]
    ds_read_b64_tr_b16 v[200:201], v211 offset:61440
    v_mfma_f32_16x16x32_bf16 v[104:107], v[168:171], a[232:235], v[104:107]
    v_mfma_f32_16x16x32_bf16 v[136:139], v[168:171], a[236:239], v[136:139]
    ds_read_b64_tr_b16 v[202:203], v211 offset:63488
    s_waitcnt lgkmcnt(14)
    v_mfma_f32_16x16x32_bf16 v[44:47], v[172:175], a[224:227], v[44:47]
    v_mfma_f32_16x16x32_bf16 v[76:79], v[172:175], a[228:231], v[76:79]
    ds_read_b64_tr_b16 v[204:205], v215 offset:61440
    v_mfma_f32_16x16x32_bf16 v[108:111], v[172:175], a[232:235], v[108:111]
    v_mfma_f32_16x16x32_bf16 v[140:143], v[172:175], a[236:239], v[140:143]
    ds_read_b64_tr_b16 v[206:207], v215 offset:63488
    s_waitcnt vmcnt(20)
    s_waitcnt lgkmcnt(14)
    v_mfma_f32_16x16x32_bf16 v[16:19], v[176:179], a[240:243], v[16:19]
    s_mov_b32 s57, 8192
    buffer_load_dwordx4 a[32:35], v2, s[72:75], s57 offen offset:0
    v_mfma_f32_16x16x32_bf16 v[48:51], v[176:179], a[244:247], v[48:51]
    v_mfma_f32_16x16x32_bf16 v[80:83], v[176:179], a[248:251], v[80:83]
    v_mfma_f32_16x16x32_bf16 v[112:115], v[176:179], a[252:255], v[112:115]
    s_waitcnt lgkmcnt(12)
    v_mfma_f32_16x16x32_bf16 v[20:23], v[180:183], a[240:243], v[20:23]
    v_mfma_f32_16x16x32_bf16 v[52:55], v[180:183], a[244:247], v[52:55]
    v_mfma_f32_16x16x32_bf16 v[84:87], v[180:183], a[248:251], v[84:87]
    v_mfma_f32_16x16x32_bf16 v[116:119], v[180:183], a[252:255], v[116:119]
    s_waitcnt lgkmcnt(10)
    v_mfma_f32_16x16x32_bf16 v[24:27], v[184:187], a[240:243], v[24:27]
    buffer_load_dwordx4 a[36:39], v2, s[72:75], s57 offen offset:1024
    v_mfma_f32_16x16x32_bf16 v[56:59], v[184:187], a[244:247], v[56:59]
    v_mfma_f32_16x16x32_bf16 v[88:91], v[184:187], a[248:251], v[88:91]
    v_mfma_f32_16x16x32_bf16 v[120:123], v[184:187], a[252:255], v[120:123]
    s_waitcnt lgkmcnt(8)
    v_mfma_f32_16x16x32_bf16 v[28:31], v[188:191], a[240:243], v[28:31]
    v_mfma_f32_16x16x32_bf16 v[60:63], v[188:191], a[244:247], v[60:63]
    v_mfma_f32_16x16x32_bf16 v[92:95], v[188:191], a[248:251], v[92:95]
    v_mfma_f32_16x16x32_bf16 v[124:127], v[188:191], a[252:255], v[124:127]
    s_waitcnt lgkmcnt(6)
    v_mfma_f32_16x16x32_bf16 v[32:35], v[192:195], a[240:243], v[32:35]
    buffer_load_dwordx4 a[40:43], v2, s[72:75], s57 offen offset:2048
    v_mfma_f32_16x16x32_bf16 v[64:67], v[192:195], a[244:247], v[64:67]
    v_mfma_f32_16x16x32_bf16 v[96:99], v[192:195], a[248:251], v[96:99]
    v_mfma_f32_16x16x32_bf16 v[128:131], v[192:195], a[252:255], v[128:131]
    s_waitcnt lgkmcnt(4)
    v_mfma_f32_16x16x32_bf16 v[36:39], v[196:199], a[240:243], v[36:39]
    v_mfma_f32_16x16x32_bf16 v[68:71], v[196:199], a[244:247], v[68:71]
    v_mfma_f32_16x16x32_bf16 v[100:103], v[196:199], a[248:251], v[100:103]
    v_mfma_f32_16x16x32_bf16 v[132:135], v[196:199], a[252:255], v[132:135]
    s_waitcnt lgkmcnt(2)
    v_mfma_f32_16x16x32_bf16 v[40:43], v[200:203], a[240:243], v[40:43]
    buffer_load_dwordx4 a[44:47], v2, s[72:75], s57 offen offset:3072
    v_mfma_f32_16x16x32_bf16 v[72:75], v[200:203], a[244:247], v[72:75]
    v_mfma_f32_16x16x32_bf16 v[104:107], v[200:203], a[248:251], v[104:107]
    v_mfma_f32_16x16x32_bf16 v[136:139], v[200:203], a[252:255], v[136:139]
    s_waitcnt lgkmcnt(0)
    v_mfma_f32_16x16x32_bf16 v[44:47], v[204:207], a[240:243], v[44:47]
    v_mfma_f32_16x16x32_bf16 v[76:79], v[204:207], a[244:247], v[76:79]
    v_mfma_f32_16x16x32_bf16 v[108:111], v[204:207], a[248:251], v[108:111]
    v_mfma_f32_16x16x32_bf16 v[140:143], v[204:207], a[252:255], v[140:143]
    s_mov_b32 s66, 0xc0135761
    s_mov_b32 s67, 0xbdd2d3e8
    s_mul_i32 s50, s47, 57344
    s_lshl_b32 s51, s46, 11
    s_add_u32 s50, s50, s51
    v_add_u32 v9, s50, v2
    s_waitcnt vmcnt(12)
    v_sub_f32 v144, 0, v248
    v_sub_f32 v145, 0, v248
    v_mul_f32 v14, v249, v249
    v_mul_f32 v152, s66, v249
    v_mul_f32 v14, v14, v249
    v_mul_f32 v153, s66, v249
    v_mul_f32 v160, s67, v14
    v_mul_f32 v161, s67, v14
    v_sub_f32 v146, 0, v250
    v_sub_f32 v147, 0, v250
    v_mul_f32 v14, v251, v251
    v_mul_f32 v154, s66, v251
    v_mul_f32 v14, v14, v251
    v_mul_f32 v155, s66, v251
    v_mul_f32 v162, s67, v14
    v_mul_f32 v163, s67, v14
    v_sub_f32 v148, 0, v252
    v_sub_f32 v149, 0, v252
    v_mul_f32 v14, v253, v253
    v_mul_f32 v156, s66, v253
    v_mul_f32 v14, v14, v253
    v_mul_f32 v157, s66, v253
    v_mul_f32 v164, s67, v14
    v_mul_f32 v165, s67, v14
    v_sub_f32 v150, 0, v254
    v_sub_f32 v151, 0, v254
    v_mul_f32 v14, v255, v255
    v_mul_f32 v158, s66, v255
    v_mul_f32 v14, v14, v255
    v_mul_f32 v159, s66, v255
    v_mul_f32 v166, s67, v14
    v_mul_f32 v167, s67, v14
    v_mov_b32 v168, 1.0
    v_mov_b32 v169, 1.0
    v_pk_fma_f32 v[16:17], v[144:145], v[216:217], v[16:17]
    v_pk_fma_f32 v[18:19], v[144:145], v[218:219], v[18:19]
    v_pk_fma_f32 v[24:25], v[144:145], v[224:225], v[24:25]
    v_pk_fma_f32 v[26:27], v[144:145], v[226:227], v[26:27]
    s_mov_b32 s57, 12288
    buffer_load_dwordx4 a[48:51], v2, s[72:75], s57 offen offset:0
    v_pk_mul_f32 v[172:173], v[16:17], v[16:17]
    v_pk_mul_f32 v[174:175], v[18:19], v[18:19]
    v_pk_mul_f32 v[176:177], v[24:25], v[24:25]
    v_pk_mul_f32 v[178:179], v[26:27], v[26:27]
    v_pk_fma_f32 v[20:21], v[144:145], v[220:221], v[20:21]
    v_pk_fma_f32 v[22:23], v[144:145], v[222:223], v[22:23]
    v_pk_fma_f32 v[28:29], v[144:145], v[228:229], v[28:29]
    v_pk_fma_f32 v[30:31], v[144:145], v[230:231], v[30:31]
    v_pk_fma_f32 v[172:173], v[172:173], v[160:161], v[152:153]
    v_pk_fma_f32 v[174:175], v[174:175], v[160:161], v[152:153]
    v_pk_fma_f32 v[176:177], v[176:177], v[160:161], v[152:153]
    v_pk_fma_f32 v[178:179], v[178:179], v[160:161], v[152:153]
    v_pk_mul_f32 v[172:173], v[172:173], v[16:17]
    v_pk_mul_f32 v[174:175], v[174:175], v[18:19]
    v_pk_mul_f32 v[176:177], v[176:177], v[24:25]
    v_pk_mul_f32 v[178:179], v[178:179], v[26:27]
    buffer_load_dwordx4 a[52:55], v2, s[72:75], s57 offen offset:1024
    v_exp_f32 v172, v172
    v_exp_f32 v173, v173
    v_exp_f32 v174, v174
    v_exp_f32 v175, v175
    v_exp_f32 v176, v176
    v_exp_f32 v177, v177
    v_exp_f32 v178, v178
    v_exp_f32 v179, v179
    v_pk_mul_f32 v[20:21], v[16:17], v[20:21]
    v_pk_mul_f32 v[22:23], v[18:19], v[22:23]
    v_pk_mul_f32 v[28:29], v[24:25], v[28:29]
    v_pk_mul_f32 v[30:31], v[26:27], v[30:31]
    v_pk_add_f32 v[172:173], v[172:173], v[168:169]
    v_pk_add_f32 v[174:175], v[174:175], v[168:169]
    v_pk_add_f32 v[176:177], v[176:177], v[168:169]
    v_pk_add_f32 v[178:179], v[178:179], v[168:169]
    v_rcp_f32 v172, v172
    v_rcp_f32 v173, v173
    v_rcp_f32 v174, v174
    v_rcp_f32 v175, v175
    v_rcp_f32 v176, v176
    v_rcp_f32 v177, v177
    v_rcp_f32 v178, v178
    v_rcp_f32 v179, v179
    v_pk_mul_f32 v[172:173], v[20:21], v[172:173]
    v_pk_mul_f32 v[174:175], v[22:23], v[174:175]
    v_pk_mul_f32 v[176:177], v[28:29], v[176:177]
    v_pk_mul_f32 v[178:179], v[30:31], v[178:179]
    v_cvt_pk_bf16_f32 v192, v172, v173
    v_cvt_pk_bf16_f32 v193, v174, v175
    v_cvt_pk_bf16_f32 v194, v176, v177
    v_cvt_pk_bf16_f32 v195, v178, v179
    s_mov_b32 s70, 0
    buffer_store_dwordx4 v[192:195], v9, s[32:35], s70 offen sc1
    v_pk_fma_f32 v[32:33], v[144:145], v[232:233], v[32:33]
    v_pk_fma_f32 v[34:35], v[144:145], v[234:235], v[34:35]
    v_pk_fma_f32 v[40:41], v[144:145], v[240:241], v[40:41]
    v_pk_fma_f32 v[42:43], v[144:145], v[242:243], v[42:43]
    buffer_load_dwordx4 a[56:59], v2, s[72:75], s57 offen offset:2048
    v_pk_mul_f32 v[172:173], v[32:33], v[32:33]
    v_pk_mul_f32 v[174:175], v[34:35], v[34:35]
    v_pk_mul_f32 v[176:177], v[40:41], v[40:41]
    v_pk_mul_f32 v[178:179], v[42:43], v[42:43]
    v_pk_fma_f32 v[36:37], v[144:145], v[236:237], v[36:37]
    v_pk_fma_f32 v[38:39], v[144:145], v[238:239], v[38:39]
    v_pk_fma_f32 v[44:45], v[144:145], v[244:245], v[44:45]
    v_pk_fma_f32 v[46:47], v[144:145], v[246:247], v[46:47]
    v_pk_fma_f32 v[172:173], v[172:173], v[160:161], v[152:153]
    v_pk_fma_f32 v[174:175], v[174:175], v[160:161], v[152:153]
    v_pk_fma_f32 v[176:177], v[176:177], v[160:161], v[152:153]
    v_pk_fma_f32 v[178:179], v[178:179], v[160:161], v[152:153]
    v_pk_mul_f32 v[172:173], v[172:173], v[32:33]
    v_pk_mul_f32 v[174:175], v[174:175], v[34:35]
    v_pk_mul_f32 v[176:177], v[176:177], v[40:41]
    v_pk_mul_f32 v[178:179], v[178:179], v[42:43]
    buffer_load_dwordx4 a[60:63], v2, s[72:75], s57 offen offset:3072
    v_exp_f32 v172, v172
    v_exp_f32 v173, v173
    v_exp_f32 v174, v174
    v_exp_f32 v175, v175
    v_exp_f32 v176, v176
    v_exp_f32 v177, v177
    v_exp_f32 v178, v178
    v_exp_f32 v179, v179
    v_pk_mul_f32 v[36:37], v[32:33], v[36:37]
    v_pk_mul_f32 v[38:39], v[34:35], v[38:39]
    v_pk_mul_f32 v[44:45], v[40:41], v[44:45]
    v_pk_mul_f32 v[46:47], v[42:43], v[46:47]
    v_pk_add_f32 v[172:173], v[172:173], v[168:169]
    v_pk_add_f32 v[174:175], v[174:175], v[168:169]
    v_pk_add_f32 v[176:177], v[176:177], v[168:169]
    v_pk_add_f32 v[178:179], v[178:179], v[168:169]
    v_rcp_f32 v172, v172
    v_rcp_f32 v173, v173
    v_rcp_f32 v174, v174
    v_rcp_f32 v175, v175
    v_rcp_f32 v176, v176
    v_rcp_f32 v177, v177
    v_rcp_f32 v178, v178
    v_rcp_f32 v179, v179
    v_pk_mul_f32 v[172:173], v[36:37], v[172:173]
    v_pk_mul_f32 v[174:175], v[38:39], v[174:175]
    v_pk_mul_f32 v[176:177], v[44:45], v[176:177]
    v_pk_mul_f32 v[178:179], v[46:47], v[178:179]
    v_cvt_pk_bf16_f32 v196, v172, v173
    v_cvt_pk_bf16_f32 v197, v174, v175
    v_cvt_pk_bf16_f32 v198, v176, v177
    v_cvt_pk_bf16_f32 v199, v178, v179
    s_mov_b32 s70, 1024
    buffer_store_dwordx4 v[196:199], v9, s[32:35], s70 offen sc1
    v_pk_fma_f32 v[48:49], v[146:147], v[216:217], v[48:49]
    v_pk_fma_f32 v[50:51], v[146:147], v[218:219], v[50:51]
    v_pk_fma_f32 v[56:57], v[146:147], v[224:225], v[56:57]
    v_pk_fma_f32 v[58:59], v[146:147], v[226:227], v[58:59]
    s_mov_b32 s57, 16384
    buffer_load_dwordx4 a[64:67], v2, s[72:75], s57 offen offset:0
    v_pk_mul_f32 v[172:173], v[48:49], v[48:49]
    v_pk_mul_f32 v[174:175], v[50:51], v[50:51]
    v_pk_mul_f32 v[176:177], v[56:57], v[56:57]
    v_pk_mul_f32 v[178:179], v[58:59], v[58:59]
    v_pk_fma_f32 v[52:53], v[146:147], v[220:221], v[52:53]
    v_pk_fma_f32 v[54:55], v[146:147], v[222:223], v[54:55]
    v_pk_fma_f32 v[60:61], v[146:147], v[228:229], v[60:61]
    v_pk_fma_f32 v[62:63], v[146:147], v[230:231], v[62:63]
    v_pk_fma_f32 v[172:173], v[172:173], v[162:163], v[154:155]
    v_pk_fma_f32 v[174:175], v[174:175], v[162:163], v[154:155]
    v_pk_fma_f32 v[176:177], v[176:177], v[162:163], v[154:155]
    v_pk_fma_f32 v[178:179], v[178:179], v[162:163], v[154:155]
    v_pk_mul_f32 v[172:173], v[172:173], v[48:49]
    v_pk_mul_f32 v[174:175], v[174:175], v[50:51]
    v_pk_mul_f32 v[176:177], v[176:177], v[56:57]
    v_pk_mul_f32 v[178:179], v[178:179], v[58:59]
    buffer_load_dwordx4 a[68:71], v2, s[72:75], s57 offen offset:1024
    v_exp_f32 v172, v172
    v_exp_f32 v173, v173
    v_exp_f32 v174, v174
    v_exp_f32 v175, v175
    v_exp_f32 v176, v176
    v_exp_f32 v177, v177
    v_exp_f32 v178, v178
    v_exp_f32 v179, v179
    v_pk_mul_f32 v[52:53], v[48:49], v[52:53]
    v_pk_mul_f32 v[54:55], v[50:51], v[54:55]
    v_pk_mul_f32 v[60:61], v[56:57], v[60:61]
    v_pk_mul_f32 v[62:63], v[58:59], v[62:63]
    v_pk_add_f32 v[172:173], v[172:173], v[168:169]
    v_pk_add_f32 v[174:175], v[174:175], v[168:169]
    v_pk_add_f32 v[176:177], v[176:177], v[168:169]
    v_pk_add_f32 v[178:179], v[178:179], v[168:169]
    v_rcp_f32 v172, v172
    v_rcp_f32 v173, v173
    v_rcp_f32 v174, v174
    v_rcp_f32 v175, v175
    v_rcp_f32 v176, v176
    v_rcp_f32 v177, v177
    v_rcp_f32 v178, v178
    v_rcp_f32 v179, v179
    v_pk_mul_f32 v[172:173], v[52:53], v[172:173]
    v_pk_mul_f32 v[174:175], v[54:55], v[174:175]
    v_pk_mul_f32 v[176:177], v[60:61], v[176:177]
    v_pk_mul_f32 v[178:179], v[62:63], v[178:179]
    v_cvt_pk_bf16_f32 v192, v172, v173
    v_cvt_pk_bf16_f32 v193, v174, v175
    v_cvt_pk_bf16_f32 v194, v176, v177
    v_cvt_pk_bf16_f32 v195, v178, v179
    s_mov_b32 s70, 57344
    buffer_store_dwordx4 v[192:195], v9, s[32:35], s70 offen sc1
    v_pk_fma_f32 v[64:65], v[146:147], v[232:233], v[64:65]
    v_pk_fma_f32 v[66:67], v[146:147], v[234:235], v[66:67]
    v_pk_fma_f32 v[72:73], v[146:147], v[240:241], v[72:73]
    v_pk_fma_f32 v[74:75], v[146:147], v[242:243], v[74:75]
    buffer_load_dwordx4 a[72:75], v2, s[72:75], s57 offen offset:2048
    v_pk_mul_f32 v[172:173], v[64:65], v[64:65]
    v_pk_mul_f32 v[174:175], v[66:67], v[66:67]
    v_pk_mul_f32 v[176:177], v[72:73], v[72:73]
    v_pk_mul_f32 v[178:179], v[74:75], v[74:75]
    v_pk_fma_f32 v[68:69], v[146:147], v[236:237], v[68:69]
    v_pk_fma_f32 v[70:71], v[146:147], v[238:239], v[70:71]
    v_pk_fma_f32 v[76:77], v[146:147], v[244:245], v[76:77]
    v_pk_fma_f32 v[78:79], v[146:147], v[246:247], v[78:79]
    v_pk_fma_f32 v[172:173], v[172:173], v[162:163], v[154:155]
    v_pk_fma_f32 v[174:175], v[174:175], v[162:163], v[154:155]
    v_pk_fma_f32 v[176:177], v[176:177], v[162:163], v[154:155]
    v_pk_fma_f32 v[178:179], v[178:179], v[162:163], v[154:155]
    v_pk_mul_f32 v[172:173], v[172:173], v[64:65]
    v_pk_mul_f32 v[174:175], v[174:175], v[66:67]
    v_pk_mul_f32 v[176:177], v[176:177], v[72:73]
    v_pk_mul_f32 v[178:179], v[178:179], v[74:75]
    buffer_load_dwordx4 a[76:79], v2, s[72:75], s57 offen offset:3072
    v_exp_f32 v172, v172
    v_exp_f32 v173, v173
    v_exp_f32 v174, v174
    v_exp_f32 v175, v175
    v_exp_f32 v176, v176
    v_exp_f32 v177, v177
    v_exp_f32 v178, v178
    v_exp_f32 v179, v179
    v_pk_mul_f32 v[68:69], v[64:65], v[68:69]
    v_pk_mul_f32 v[70:71], v[66:67], v[70:71]
    v_pk_mul_f32 v[76:77], v[72:73], v[76:77]
    v_pk_mul_f32 v[78:79], v[74:75], v[78:79]
    v_pk_add_f32 v[172:173], v[172:173], v[168:169]
    v_pk_add_f32 v[174:175], v[174:175], v[168:169]
    v_pk_add_f32 v[176:177], v[176:177], v[168:169]
    v_pk_add_f32 v[178:179], v[178:179], v[168:169]
    v_rcp_f32 v172, v172
    v_rcp_f32 v173, v173
    v_rcp_f32 v174, v174
    v_rcp_f32 v175, v175
    v_rcp_f32 v176, v176
    v_rcp_f32 v177, v177
    v_rcp_f32 v178, v178
    v_rcp_f32 v179, v179
    v_pk_mul_f32 v[172:173], v[68:69], v[172:173]
    v_pk_mul_f32 v[174:175], v[70:71], v[174:175]
    v_pk_mul_f32 v[176:177], v[76:77], v[176:177]
    v_pk_mul_f32 v[178:179], v[78:79], v[178:179]
    v_cvt_pk_bf16_f32 v196, v172, v173
    v_cvt_pk_bf16_f32 v197, v174, v175
    v_cvt_pk_bf16_f32 v198, v176, v177
    v_cvt_pk_bf16_f32 v199, v178, v179
    s_mov_b32 s70, 58368
    buffer_store_dwordx4 v[196:199], v9, s[32:35], s70 offen sc1
    v_pk_fma_f32 v[80:81], v[148:149], v[216:217], v[80:81]
    v_pk_fma_f32 v[82:83], v[148:149], v[218:219], v[82:83]
    v_pk_fma_f32 v[88:89], v[148:149], v[224:225], v[88:89]
    v_pk_fma_f32 v[90:91], v[148:149], v[226:227], v[90:91]
    s_mov_b32 s57, 20480
    buffer_load_dwordx4 a[80:83], v2, s[72:75], s57 offen offset:0
    v_pk_mul_f32 v[172:173], v[80:81], v[80:81]
    v_pk_mul_f32 v[174:175], v[82:83], v[82:83]
    v_pk_mul_f32 v[176:177], v[88:89], v[88:89]
    v_pk_mul_f32 v[178:179], v[90:91], v[90:91]
    v_pk_fma_f32 v[84:85], v[148:149], v[220:221], v[84:85]
    v_pk_fma_f32 v[86:87], v[148:149], v[222:223], v[86:87]
    v_pk_fma_f32 v[92:93], v[148:149], v[228:229], v[92:93]
    v_pk_fma_f32 v[94:95], v[148:149], v[230:231], v[94:95]
    v_pk_fma_f32 v[172:173], v[172:173], v[164:165], v[156:157]
    v_pk_fma_f32 v[174:175], v[174:175], v[164:165], v[156:157]
    v_pk_fma_f32 v[176:177], v[176:177], v[164:165], v[156:157]
    v_pk_fma_f32 v[178:179], v[178:179], v[164:165], v[156:157]
    v_pk_mul_f32 v[172:173], v[172:173], v[80:81]
    v_pk_mul_f32 v[174:175], v[174:175], v[82:83]
    v_pk_mul_f32 v[176:177], v[176:177], v[88:89]
    v_pk_mul_f32 v[178:179], v[178:179], v[90:91]
    buffer_load_dwordx4 a[84:87], v2, s[72:75], s57 offen offset:1024
    v_exp_f32 v172, v172
    v_exp_f32 v173, v173
    v_exp_f32 v174, v174
    v_exp_f32 v175, v175
    v_exp_f32 v176, v176
    v_exp_f32 v177, v177
    v_exp_f32 v178, v178
    v_exp_f32 v179, v179
    v_pk_mul_f32 v[84:85], v[80:81], v[84:85]
    v_pk_mul_f32 v[86:87], v[82:83], v[86:87]
    v_pk_mul_f32 v[92:93], v[88:89], v[92:93]
    v_pk_mul_f32 v[94:95], v[90:91], v[94:95]
    v_pk_add_f32 v[172:173], v[172:173], v[168:169]
    v_pk_add_f32 v[174:175], v[174:175], v[168:169]
    v_pk_add_f32 v[176:177], v[176:177], v[168:169]
    v_pk_add_f32 v[178:179], v[178:179], v[168:169]
    v_rcp_f32 v172, v172
    v_rcp_f32 v173, v173
    v_rcp_f32 v174, v174
    v_rcp_f32 v175, v175
    v_rcp_f32 v176, v176
    v_rcp_f32 v177, v177
    v_rcp_f32 v178, v178
    v_rcp_f32 v179, v179
    v_pk_mul_f32 v[172:173], v[84:85], v[172:173]
    v_pk_mul_f32 v[174:175], v[86:87], v[174:175]
    v_pk_mul_f32 v[176:177], v[92:93], v[176:177]
    v_pk_mul_f32 v[178:179], v[94:95], v[178:179]
    v_cvt_pk_bf16_f32 v192, v172, v173
    v_cvt_pk_bf16_f32 v193, v174, v175
    v_cvt_pk_bf16_f32 v194, v176, v177
    v_cvt_pk_bf16_f32 v195, v178, v179
    s_mov_b32 s70, 114688
    buffer_store_dwordx4 v[192:195], v9, s[32:35], s70 offen sc1
    v_pk_fma_f32 v[96:97], v[148:149], v[232:233], v[96:97]
    v_pk_fma_f32 v[98:99], v[148:149], v[234:235], v[98:99]
    v_pk_fma_f32 v[104:105], v[148:149], v[240:241], v[104:105]
    v_pk_fma_f32 v[106:107], v[148:149], v[242:243], v[106:107]
    buffer_load_dwordx4 a[88:91], v2, s[72:75], s57 offen offset:2048
    v_pk_mul_f32 v[172:173], v[96:97], v[96:97]
    v_pk_mul_f32 v[174:175], v[98:99], v[98:99]
    v_pk_mul_f32 v[176:177], v[104:105], v[104:105]
    v_pk_mul_f32 v[178:179], v[106:107], v[106:107]
    v_pk_fma_f32 v[100:101], v[148:149], v[236:237], v[100:101]
    v_pk_fma_f32 v[102:103], v[148:149], v[238:239], v[102:103]
    v_pk_fma_f32 v[108:109], v[148:149], v[244:245], v[108:109]
    v_pk_fma_f32 v[110:111], v[148:149], v[246:247], v[110:111]
    v_pk_fma_f32 v[172:173], v[172:173], v[164:165], v[156:157]
    v_pk_fma_f32 v[174:175], v[174:175], v[164:165], v[156:157]
    v_pk_fma_f32 v[176:177], v[176:177], v[164:165], v[156:157]
    v_pk_fma_f32 v[178:179], v[178:179], v[164:165], v[156:157]
    v_pk_mul_f32 v[172:173], v[172:173], v[96:97]
    v_pk_mul_f32 v[174:175], v[174:175], v[98:99]
    v_pk_mul_f32 v[176:177], v[176:177], v[104:105]
    v_pk_mul_f32 v[178:179], v[178:179], v[106:107]
    buffer_load_dwordx4 a[92:95], v2, s[72:75], s57 offen offset:3072
    v_exp_f32 v172, v172
    v_exp_f32 v173, v173
    v_exp_f32 v174, v174
    v_exp_f32 v175, v175
    v_exp_f32 v176, v176
    v_exp_f32 v177, v177
    v_exp_f32 v178, v178
    v_exp_f32 v179, v179
    v_pk_mul_f32 v[100:101], v[96:97], v[100:101]
    v_pk_mul_f32 v[102:103], v[98:99], v[102:103]
    v_pk_mul_f32 v[108:109], v[104:105], v[108:109]
    v_pk_mul_f32 v[110:111], v[106:107], v[110:111]
    v_pk_add_f32 v[172:173], v[172:173], v[168:169]
    v_pk_add_f32 v[174:175], v[174:175], v[168:169]
    v_pk_add_f32 v[176:177], v[176:177], v[168:169]
    v_pk_add_f32 v[178:179], v[178:179], v[168:169]
    v_rcp_f32 v172, v172
    v_rcp_f32 v173, v173
    v_rcp_f32 v174, v174
    v_rcp_f32 v175, v175
    v_rcp_f32 v176, v176
    v_rcp_f32 v177, v177
    v_rcp_f32 v178, v178
    v_rcp_f32 v179, v179
    v_pk_mul_f32 v[172:173], v[100:101], v[172:173]
    v_pk_mul_f32 v[174:175], v[102:103], v[174:175]
    v_pk_mul_f32 v[176:177], v[108:109], v[176:177]
    v_pk_mul_f32 v[178:179], v[110:111], v[178:179]
    v_cvt_pk_bf16_f32 v196, v172, v173
    v_cvt_pk_bf16_f32 v197, v174, v175
    v_cvt_pk_bf16_f32 v198, v176, v177
    v_cvt_pk_bf16_f32 v199, v178, v179
    s_mov_b32 s70, 115712
    buffer_store_dwordx4 v[196:199], v9, s[32:35], s70 offen sc1
    v_pk_fma_f32 v[112:113], v[150:151], v[216:217], v[112:113]
    v_pk_fma_f32 v[114:115], v[150:151], v[218:219], v[114:115]
    v_pk_fma_f32 v[120:121], v[150:151], v[224:225], v[120:121]
    v_pk_fma_f32 v[122:123], v[150:151], v[226:227], v[122:123]
    s_mov_b32 s57, 24576
    buffer_load_dwordx4 a[96:99], v2, s[72:75], s57 offen offset:0
    v_pk_mul_f32 v[172:173], v[112:113], v[112:113]
    v_pk_mul_f32 v[174:175], v[114:115], v[114:115]
    v_pk_mul_f32 v[176:177], v[120:121], v[120:121]
    v_pk_mul_f32 v[178:179], v[122:123], v[122:123]
    v_pk_fma_f32 v[116:117], v[150:151], v[220:221], v[116:117]
    v_pk_fma_f32 v[118:119], v[150:151], v[222:223], v[118:119]
    v_pk_fma_f32 v[124:125], v[150:151], v[228:229], v[124:125]
    v_pk_fma_f32 v[126:127], v[150:151], v[230:231], v[126:127]
    v_pk_fma_f32 v[172:173], v[172:173], v[166:167], v[158:159]
    v_pk_fma_f32 v[174:175], v[174:175], v[166:167], v[158:159]
    v_pk_fma_f32 v[176:177], v[176:177], v[166:167], v[158:159]
    v_pk_fma_f32 v[178:179], v[178:179], v[166:167], v[158:159]
    v_pk_mul_f32 v[172:173], v[172:173], v[112:113]
    v_pk_mul_f32 v[174:175], v[174:175], v[114:115]
    v_pk_mul_f32 v[176:177], v[176:177], v[120:121]
    v_pk_mul_f32 v[178:179], v[178:179], v[122:123]
    buffer_load_dwordx4 a[100:103], v2, s[72:75], s57 offen offset:1024
    v_exp_f32 v172, v172
    v_exp_f32 v173, v173
    v_exp_f32 v174, v174
    v_exp_f32 v175, v175
    v_exp_f32 v176, v176
    v_exp_f32 v177, v177
    v_exp_f32 v178, v178
    v_exp_f32 v179, v179
    v_pk_mul_f32 v[116:117], v[112:113], v[116:117]
    v_pk_mul_f32 v[118:119], v[114:115], v[118:119]
    v_pk_mul_f32 v[124:125], v[120:121], v[124:125]
    v_pk_mul_f32 v[126:127], v[122:123], v[126:127]
    v_pk_add_f32 v[172:173], v[172:173], v[168:169]
    v_pk_add_f32 v[174:175], v[174:175], v[168:169]
    v_pk_add_f32 v[176:177], v[176:177], v[168:169]
    v_pk_add_f32 v[178:179], v[178:179], v[168:169]
    v_rcp_f32 v172, v172
    v_rcp_f32 v173, v173
    v_rcp_f32 v174, v174
    v_rcp_f32 v175, v175
    v_rcp_f32 v176, v176
    v_rcp_f32 v177, v177
    v_rcp_f32 v178, v178
    v_rcp_f32 v179, v179
    v_pk_mul_f32 v[172:173], v[116:117], v[172:173]
    v_pk_mul_f32 v[174:175], v[118:119], v[174:175]
    v_pk_mul_f32 v[176:177], v[124:125], v[176:177]
    v_pk_mul_f32 v[178:179], v[126:127], v[178:179]
    v_cvt_pk_bf16_f32 v192, v172, v173
    v_cvt_pk_bf16_f32 v193, v174, v175
    v_cvt_pk_bf16_f32 v194, v176, v177
    v_cvt_pk_bf16_f32 v195, v178, v179
    s_mov_b32 s70, 172032
    buffer_store_dwordx4 v[192:195], v9, s[32:35], s70 offen sc1
    s_waitcnt vmcnt(9)
    s_barrier
    s_cmp_lg_u32 s44, 0
    s_cbranch_scc1 g_nosig0
    s_lshl_b32 s50, s45, 8
    s_add_u32 s50, s50, 2048
    v_mov_b32 v12, s50
    v_mov_b32 v13, 1
    s_mov_b64 exec, 1
    global_atomic_add v12, v13, s[14:15] sc1
    s_mov_b64 exec, -1
g_nosig0:
    v_pk_fma_f32 v[128:129], v[150:151], v[232:233], v[128:129]
    v_pk_fma_f32 v[130:131], v[150:151], v[234:235], v[130:131]
    v_pk_fma_f32 v[136:137], v[150:151], v[240:241], v[136:137]
    v_pk_fma_f32 v[138:139], v[150:151], v[242:243], v[138:139]
    buffer_load_dwordx4 a[104:107], v2, s[72:75], s57 offen offset:2048
    v_pk_mul_f32 v[172:173], v[128:129], v[128:129]
    v_pk_mul_f32 v[174:175], v[130:131], v[130:131]
    v_pk_mul_f32 v[176:177], v[136:137], v[136:137]
    v_pk_mul_f32 v[178:179], v[138:139], v[138:139]
    v_pk_fma_f32 v[132:133], v[150:151], v[236:237], v[132:133]
    v_pk_fma_f32 v[134:135], v[150:151], v[238:239], v[134:135]
    v_pk_fma_f32 v[140:141], v[150:151], v[244:245], v[140:141]
    v_pk_fma_f32 v[142:143], v[150:151], v[246:247], v[142:143]
    v_pk_fma_f32 v[172:173], v[172:173], v[166:167], v[158:159]
    v_pk_fma_f32 v[174:175], v[174:175], v[166:167], v[158:159]
    v_pk_fma_f32 v[176:177], v[176:177], v[166:167], v[158:159]
    v_pk_fma_f32 v[178:179], v[178:179], v[166:167], v[158:159]
    v_pk_mul_f32 v[172:173], v[172:173], v[128:129]
    v_pk_mul_f32 v[174:175], v[174:175], v[130:131]
    v_pk_mul_f32 v[176:177], v[176:177], v[136:137]
    v_pk_mul_f32 v[178:179], v[178:179], v[138:139]
    buffer_load_dwordx4 a[108:111], v2, s[72:75], s57 offen offset:3072
    v_exp_f32 v172, v172
    v_exp_f32 v173, v173
    v_exp_f32 v174, v174
    v_exp_f32 v175, v175
    v_exp_f32 v176, v176
    v_exp_f32 v177, v177
    v_exp_f32 v178, v178
    v_exp_f32 v179, v179
    v_pk_mul_f32 v[132:133], v[128:129], v[132:133]
    v_pk_mul_f32 v[134:135], v[130:131], v[134:135]
    v_pk_mul_f32 v[140:141], v[136:137], v[140:141]
    v_pk_mul_f32 v[142:143], v[138:139], v[142:143]
    v_pk_add_f32 v[172:173], v[172:173], v[168:169]
    v_pk_add_f32 v[174:175], v[174:175], v[168:169]
    v_pk_add_f32 v[176:177], v[176:177], v[168:169]
    v_pk_add_f32 v[178:179], v[178:179], v[168:169]
    v_rcp_f32 v172, v172
    v_rcp_f32 v173, v173
    v_rcp_f32 v174, v174
    v_rcp_f32 v175, v175
    v_rcp_f32 v176, v176
    v_rcp_f32 v177, v177
    v_rcp_f32 v178, v178
    v_rcp_f32 v179, v179
    v_pk_mul_f32 v[172:173], v[132:133], v[172:173]
    v_pk_mul_f32 v[174:175], v[134:135], v[174:175]
    v_pk_mul_f32 v[176:177], v[140:141], v[176:177]
    v_pk_mul_f32 v[178:179], v[142:143], v[178:179]
    v_cvt_pk_bf16_f32 v196, v172, v173
    v_cvt_pk_bf16_f32 v197, v174, v175
    v_cvt_pk_bf16_f32 v198, v176, v177
    v_cvt_pk_bf16_f32 v199, v178, v179
    s_mov_b32 s70, 173056
    buffer_store_dwordx4 v[196:199], v9, s[32:35], s70 offen sc1
g_part2:
    s_mov_b32 s57, 28672
    buffer_load_dwordx4 a[112:115], v2, s[72:75], s57 offen offset:0
    buffer_load_dwordx4 a[116:119], v2, s[72:75], s57 offen offset:1024
    buffer_load_dwordx4 a[120:123], v2, s[72:75], s57 offen offset:2048
    buffer_load_dwordx4 a[124:127], v2, s[72:75], s57 offen offset:3072
    s_mov_b32 s57, 32768
    buffer_load_dwordx4 a[128:131], v2, s[72:75], s57 offen offset:0
    buffer_load_dwordx4 a[132:135], v2, s[72:75], s57 offen offset:1024
    buffer_load_dwordx4 a[136:139], v2, s[72:75], s57 offen offset:2048
    buffer_load_dwordx4 a[140:143], v2, s[72:75], s57 offen offset:3072
    s_mov_b32 s57, 36864
    buffer_load_dwordx4 a[144:147], v2, s[72:75], s57 offen offset:0
    buffer_load_dwordx4 a[148:151], v2, s[72:75], s57 offen offset:1024
    buffer_load_dwordx4 a[152:155], v2, s[72:75], s57 offen offset:2048
    buffer_load_dwordx4 a[156:159], v2, s[72:75], s57 offen offset:3072
    s_waitcnt vmcnt(12)
    s_barrier
    s_cmp_eq_u32 s43, 0
    s_cbranch_scc1 g_nosig
    s_cmp_lg_u32 s44, 0
    s_cbranch_scc1 g_nosig
    s_lshl_b32 s50, s45, 8
    s_add_u32 s50, s50, 4096
    v_mov_b32 v12, s50
    v_mov_b32 v13, 1
    s_mov_b64 exec, 1
    global_atomic_add v12, v13, s[14:15] sc1
    s_mov_b64 exec, -1
g_nosig:
    s_lshr_b32 s50, s40, 2
    s_lshl_b32 s50, s50, 8
    s_add_u32 s50, s50, 2048
    v_mov_b32 v198, s50
    global_load_dword v199, v198, s[14:15] sc1
    s_mov_b32 s57, 40960
    buffer_load_dwordx4 a[160:163], v2, s[72:75], s57 offen offset:0
    buffer_load_dwordx4 a[164:167], v2, s[72:75], s57 offen offset:1024
    buffer_load_dwordx4 a[168:171], v2, s[72:75], s57 offen offset:2048
    buffer_load_dwordx4 a[172:175], v2, s[72:75], s57 offen offset:3072
    s_mov_b32 s57, 45056
    buffer_load_dwordx4 a[176:179], v2, s[72:75], s57 offen offset:0
    buffer_load_dwordx4 a[180:183], v2, s[72:75], s57 offen offset:1024
    buffer_load_dwordx4 a[184:187], v2, s[72:75], s57 offen offset:2048
    buffer_load_dwordx4 a[188:191], v2, s[72:75], s57 offen offset:3072
    s_mov_b32 s57, 49152
    buffer_load_dwordx4 a[192:195], v2, s[72:75], s57 offen offset:0
    buffer_load_dwordx4 a[196:199], v2, s[72:75], s57 offen offset:1024
    buffer_load_dwordx4 a[200:203], v2, s[72:75], s57 offen offset:2048
    buffer_load_dwordx4 a[204:207], v2, s[72:75], s57 offen offset:3072
    s_mov_b32 s57, 53248
    buffer_load_dwordx4 a[208:211], v2, s[72:75], s57 offen offset:0
    buffer_load_dwordx4 a[212:215], v2, s[72:75], s57 offen offset:1024
    buffer_load_dwordx4 a[216:219], v2, s[72:75], s57 offen offset:2048
    buffer_load_dwordx4 a[220:223], v2, s[72:75], s57 offen offset:3072
    s_mul_i32 s47, s44, 14
    s_mul_i32 s49, s40, 224
    s_add_u32 s49, s49, s47
    s_lshl_b32 s49, s49, 10
    s_add_u32 s50, s49, 16777216
    s_add_u32 s20, s12, s50
    s_addc_u32 s21, s13, 0
    s_mov_b32 s22, 186368
    s_mov_b32 s23, 131072
    v_add_u32 v4, 0, v2
    v_add_u32 v5, 57344, v2
    v_add_u32 v6, 114688, v2
    v_add_u32 v7, 172032, v2
    s_add_u32 s24, s12, 4194304
    s_addc_u32 s25, s13, 0
    s_mov_b32 s26, 2097152
    s_mov_b32 s27, 131072
    s_mov_b32 s28, s10
    s_mov_b32 s29, s11
    s_mov_b32 s30, 2097152
    s_mov_b32 s31, 131072
    s_add_u32 s36, s12, 6422528
    s_addc_u32 s37, s13, 0
    s_mov_b32 s38, 16384
    s_mov_b32 s39, 131072
    s_lshr_b32 s50, s44, 1
    s_and_b32 s53, s44, 1
    s_lshl_b32 s51, s40, 2
    s_add_u32 s50, s50, s51
    s_lshl_b32 s51, s50, 14
    s_lshl_b32 s54, s41, 11
    s_add_u32 s51, s51, s54
    s_lshl_b32 s54, s53, 10
    s_add_u32 s51, s51, s54
    v_add_u32 v10, s51, v2
    s_lshl_b32 s51, s50, 14
    s_lshl_b32 s54, s41, 7
    s_add_u32 s51, s51, s54
    s_lshl_b32 s54, s53, 6
    s_add_u32 s51, s51, s54
    v_lshrrev_b32 v8, 4, v1
    v_and_b32 v9, 15, v1
    v_lshlrev_b32 v11, 10, v9
    v_and_b32 v12, 1, v8
    v_lshl_add_u32 v11, v12, 5, v11
    v_lshrrev_b32 v12, 1, v8
    v_lshl_add_u32 v11, v12, 4, v11
    v_add_u32 v11, s51, v11
    s_lshl_b32 s51, s50, 7
    v_lshl_add_u32 v14, v9, 3, s51
    s_lshl_b32 s51, s44, 10
    v_add_u32 v190, s51, v2
    s_lshl_b32 s51, s44, 13
    v_add_u32 v191, s51, v2
    s_mov_b32 s55, 32768
    buffer_load_dwordx4 v[176:179], v10, s[24:27], 0 offen
    buffer_load_dwordx4 v[184:187], v10, s[24:27], s55 offen
    s_waitcnt vmcnt(18)
    s_cmp_lg_u32 s44, 0
    s_cbranch_scc1 g_joined
    v_readfirstlane_b32 s50, v199
    s_nop 0
    s_cmp_ge_u32 s50, 28
    s_cbranch_scc1 g_joined
    s_mov_b32 s51, 0
g_poll2:
    global_load_dword v199, v198, s[14:15] sc1
    s_add_u32 s51, s51, 1
    s_waitcnt vmcnt(0)
    v_readfirstlane_b32 s50, v199
    s_nop 0
    s_cmp_ge_u32 s50, 28
    s_cbranch_scc1 g_joined
    s_cmp_lt_u32 s51, 200000
    s_cbranch_scc0 g_joined
    s_sleep 1
    s_branch g_poll2
g_joined:
    s_barrier
    buffer_load_dword v180, v14, s[36:39], 0 offen offset:4 sc1
    buffer_load_dword v188, v14, s[36:39], 0 offen offset:260 sc1
    s_lshr_b32 s50, s40, 2
    s_lshl_b32 s50, s50, 8
    s_add_u32 s50, s50, 4096
    v_mov_b32 v12, s50
    s_mov_b32 s51, 0
    buffer_load_dwordx4 v[80:83], v4, s[20:23], s51 offen sc1
    buffer_load_dwordx4 v[84:87], v5, s[20:23], s51 offen sc1
    s_mov_b32 s51, 1024
    buffer_load_dwordx4 v[88:91], v4, s[20:23], s51 offen sc1
    buffer_load_dwordx4 v[92:95], v5, s[20:23], s51 offen sc1
    s_mov_b32 s51, 2048
    buffer_load_dwordx4 v[96:99], v4, s[20:23], s51 offen sc1
    buffer_load_dwordx4 v[100:103], v5, s[20:23], s51 offen sc1
    s_mov_b32 s51, 3072
    buffer_load_dwordx4 v[104:107], v4, s[20:23], s51 offen sc1
    buffer_load_dwordx4 v[108:111], v5, s[20:23], s51 offen sc1
    s_mov_b32 s51, 4096
    buffer_load_dwordx4 v[112:115], v4, s[20:23], s51 offen sc1
    buffer_load_dwordx4 v[116:119], v5, s[20:23], s51 offen sc1
    s_mov_b32 s51, 5120
    buffer_load_dwordx4 v[120:123], v4, s[20:23], s51 offen sc1
    buffer_load_dwordx4 v[124:127], v5, s[20:23], s51 offen sc1
    s_waitcnt vmcnt(10)
    v_mfma_f32_16x16x32_bf16 v[16:19], a[0:3], v[80:83], 0
    v_mfma_f32_16x16x32_bf16 v[20:23], a[4:7], v[80:83], 0
    s_mov_b32 s51, 6144
    buffer_load_dwordx4 v[128:131], v4, s[20:23], s51 offen sc1
    v_mfma_f32_16x16x32_bf16 v[24:27], a[8:11], v[80:83], 0
    v_mfma_f32_16x16x32_bf16 v[28:31], a[12:15], v[80:83], 0
    v_mfma_f32_16x16x32_bf16 v[32:35], a[0:3], v[84:87], 0
    v_mfma_f32_16x16x32_bf16 v[36:39], a[4:7], v[84:87], 0
    buffer_load_dwordx4 v[132:135], v5, s[20:23], s51 offen sc1
    v_mfma_f32_16x16x32_bf16 v[40:43], a[8:11], v[84:87], 0
    v_mfma_f32_16x16x32_bf16 v[44:47], a[12:15], v[84:87], 0
    s_waitcnt vmcnt(10)
    v_mfma_f32_16x16x32_bf16 v[16:19], a[16:19], v[88:91], v[16:19]
    v_mfma_f32_16x16x32_bf16 v[20:23], a[20:23], v[88:91], v[20:23]
    s_mov_b32 s51, 7168
    buffer_load_dwordx4 v[80:83], v4, s[20:23], s51 offen sc1
    v_mfma_f32_16x16x32_bf16 v[24:27], a[24:27], v[88:91], v[24:27]
    v_mfma_f32_16x16x32_bf16 v[28:31], a[28:31], v[88:91], v[28:31]
    v_mfma_f32_16x16x32_bf16 v[32:35], a[16:19], v[92:95], v[32:35]
    v_mfma_f32_16x16x32_bf16 v[36:39], a[20:23], v[92:95], v[36:39]
    buffer_load_dwordx4 v[84:87], v5, s[20:23], s51 offen sc1
    v_mfma_f32_16x16x32_bf16 v[40:43], a[24:27], v[92:95], v[40:43]
    v_mfma_f32_16x16x32_bf16 v[44:47], a[28:31], v[92:95], v[44:47]
    s_waitcnt vmcnt(10)
    v_mfma_f32_16x16x32_bf16 v[16:19], a[32:35], v[96:99], v[16:19]
    v_mfma_f32_16x16x32_bf16 v[20:23], a[36:39], v[96:99], v[20:23]
    s_mov_b32 s51, 8192
    buffer_load_dwordx4 v[88:91], v4, s[20:23], s51 offen sc1
    v_mfma_f32_16x16x32_bf16 v[24:27], a[40:43], v[96:99], v[24:27]
    v_mfma_f32_16x16x32_bf16 v[28:31], a[44:47], v[96:99], v[28:31]
    v_mfma_f32_16x16x32_bf16 v[32:35], a[32:35], v[100:103], v[32:35]
    v_mfma_f32_16x16x32_bf16 v[36:39], a[36:39], v[100:103], v[36:39]
    buffer_load_dwordx4 v[92:95], v5, s[20:23], s51 offen sc1
    v_mfma_f32_16x16x32_bf16 v[40:43], a[40:43], v[100:103], v[40:43]
    v_mfma_f32_16x16x32_bf16 v[44:47], a[44:47], v[100:103], v[44:47]
    s_waitcnt vmcnt(10)
    v_mfma_f32_16x16x32_bf16 v[16:19], a[48:51], v[104:107], v[16:19]
    v_mfma_f32_16x16x32_bf16 v[20:23], a[52:55], v[104:107], v[20:23]
    s_mov_b32 s51, 9216
    buffer_load_dwordx4 v[96:99], v4, s[20:23], s51 offen sc1
    v_mfma_f32_16x16x32_bf16 v[24:27], a[56:59], v[104:107], v[24:27]
    v_mfma_f32_16x16x32_bf16 v[28:31], a[60:63], v[104:107], v[28:31]
    v_mfma_f32_16x16x32_bf16 v[32:35], a[48:51], v[108:111], v[32:35]
    v_mfma_f32_16x16x32_bf16 v[36:39], a[52:55], v[108:111], v[36:39]
    buffer_load_dwordx4 v[100:103], v5, s[20:23], s51 offen sc1
    v_mfma_f32_16x16x32_bf16 v[40:43], a[56:59], v[108:111], v[40:43]
    v_mfma_f32_16x16x32_bf16 v[44:47], a[60:63], v[108:111], v[44:47]
    s_waitcnt vmcnt(10)
    v_mfma_f32_16x16x32_bf16 v[16:19], a[64:67], v[112:115], v[16:19]
    v_mfma_f32_16x16x32_bf16 v[20:23], a[68:71], v[112:115], v[20:23]
    s_mov_b32 s51, 10240
    buffer_load_dwordx4 v[104:107], v4, s[20:23], s51 offen sc1
    v_mfma_f32_16x16x32_bf16 v[24:27], a[72:75], v[112:115], v[24:27]
    v_mfma_f32_16x16x32_bf16 v[28:31], a[76:79], v[112:115], v[28:31]
    v_mfma_f32_16x16x32_bf16 v[32:35], a[64:67], v[116:119], v[32:35]
    v_mfma_f32_16x16x32_bf16 v[36:39], a[68:71], v[116:119], v[36:39]
    buffer_load_dwordx4 v[108:111], v5, s[20:23], s51 offen sc1
    v_mfma_f32_16x16x32_bf16 v[40:43], a[72:75], v[116:119], v[40:43]
    v_mfma_f32_16x16x32_bf16 v[44:47], a[76:79], v[116:119], v[44:47]
    global_load_dword v13, v12, s[14:15] sc1
    s_waitcnt vmcnt(11)
    v_mfma_f32_16x16x32_bf16 v[16:19], a[80:83], v[120:123], v[16:19]
    v_mfma_f32_16x16x32_bf16 v[20:23], a[84:87], v[120:123], v[20:23]
    s_mov_b32 s51, 11264
    buffer_load_dwordx4 v[112:115], v4, s[20:23], s51 offen sc1
    v_mfma_f32_16x16x32_bf16 v[24:27], a[88:91], v[120:123], v[24:27]
    v_mfma_f32_16x16x32_bf16 v[28:31], a[92:95], v[120:123], v[28:31]
    v_mfma_f32_16x16x32_bf16 v[32:35], a[80:83], v[124:127], v[32:35]
    v_mfma_f32_16x16x32_bf16 v[36:39], a[84:87], v[124:127], v[36:39]
    buffer_load_dwordx4 v[116:119], v5, s[20:23], s51 offen sc1
    v_mfma_f32_16x16x32_bf16 v[40:43], a[88:91], v[124:127], v[40:43]
    v_mfma_f32_16x16x32_bf16 v[44:47], a[92:95], v[124:127], v[44:47]
    s_waitcnt vmcnt(11)
    v_mfma_f32_16x16x32_bf16 v[16:19], a[96:99], v[128:131], v[16:19]
    v_mfma_f32_16x16x32_bf16 v[20:23], a[100:103], v[128:131], v[20:23]
    s_mov_b32 s51, 12288
    buffer_load_dwordx4 v[120:123], v4, s[20:23], s51 offen sc1
    v_mfma_f32_16x16x32_bf16 v[24:27], a[104:107], v[128:131], v[24:27]
    v_mfma_f32_16x16x32_bf16 v[28:31], a[108:111], v[128:131], v[28:31]
    v_mfma_f32_16x16x32_bf16 v[32:35], a[96:99], v[132:135], v[32:35]
    v_mfma_f32_16x16x32_bf16 v[36:39], a[100:103], v[132:135], v[36:39]
    buffer_load_dwordx4 v[124:127], v5, s[20:23], s51 offen sc1
    v_mfma_f32_16x16x32_bf16 v[40:43], a[104:107], v[132:135], v[40:43]
    v_mfma_f32_16x16x32_bf16 v[44:47], a[108:111], v[132:135], v[44:47]
    s_waitcnt vmcnt(11)
    v_mfma_f32_16x16x32_bf16 v[16:19], a[112:115], v[80:83], v[16:19]
    v_mfma_f32_16x16x32_bf16 v[20:23], a[116:119], v[80:83], v[20:23]
    s_mov_b32 s51, 13312
    buffer_load_dwordx4 v[128:131], v4, s[20:23], s51 offen sc1
    v_mfma_f32_16x16x32_bf16 v[24:27], a[120:123], v[80:83], v[24:27]
    v_mfma_f32_16x16x32_bf16 v[28:31], a[124:127], v[80:83], v[28:31]
    v_mfma_f32_16x16x32_bf16 v[32:35], a[112:115], v[84:87], v[32:35]
    v_mfma_f32_16x16x32_bf16 v[36:39], a[116:119], v[84:87], v[36:39]
    buffer_load_dwordx4 v[132:135], v5, s[20:23], s51 offen sc1
    v_mfma_f32_16x16x32_bf16 v[40:43], a[120:123], v[84:87], v[40:43]
    v_mfma_f32_16x16x32_bf16 v[44:47], a[124:127], v[84:87], v[44:47]
    s_waitcnt vmcnt(6)
    v_readfirstlane_b32 s50, v13
    s_mov_b32 s53, 0
    s_cmp_ge_u32 s50, 28
    s_cbranch_scc1 g_ready1
g_poll3:
    global_load_dword v13, v12, s[14:15] sc1
    s_add_u32 s53, s53, 1
    s_waitcnt vmcnt(0)
    v_readfirstlane_b32 s50, v13
    s_nop 0
    s_cmp_ge_u32 s50, 28
    s_cbranch_scc1 g_ready1
    s_cmp_lt_u32 s53, 200000
    s_cbranch_scc0 g_ready1
    s_sleep 1
    s_branch g_poll3
g_ready1:
    s_waitcnt vmcnt(11)
    v_mfma_f32_16x16x32_bf16 v[16:19], a[128:131], v[88:91], v[16:19]
    v_mfma_f32_16x16x32_bf16 v[20:23], a[132:135], v[88:91], v[20:23]
    s_mov_b32 s51, 0
    buffer_load_dwordx4 v[80:83], v6, s[20:23], s51 offen sc1
    v_mfma_f32_16x16x32_bf16 v[24:27], a[136:139], v[88:91], v[24:27]
    v_mfma_f32_16x16x32_bf16 v[28:31], a[140:143], v[88:91], v[28:31]
    v_mfma_f32_16x16x32_bf16 v[32:35], a[128:131], v[92:95], v[32:35]
    v_mfma_f32_16x16x32_bf16 v[36:39], a[132:135], v[92:95], v[36:39]
    buffer_load_dwordx4 v[84:87], v7, s[20:23], s51 offen sc1
    v_mfma_f32_16x16x32_bf16 v[40:43], a[136:139], v[92:95], v[40:43]
    v_mfma_f32_16x16x32_bf16 v[44:47], a[140:143], v[92:95], v[44:47]
    s_waitcnt vmcnt(11)
    v_mfma_f32_16x16x32_bf16 v[16:19], a[144:147], v[96:99], v[16:19]
    v_mfma_f32_16x16x32_bf16 v[20:23], a[148:151], v[96:99], v[20:23]
    s_mov_b32 s51, 1024
    buffer_load_dwordx4 v[88:91], v6, s[20:23], s51 offen sc1
    v_mfma_f32_16x16x32_bf16 v[24:27], a[152:155], v[96:99], v[24:27]
    v_mfma_f32_16x16x32_bf16 v[28:31], a[156:159], v[96:99], v[28:31]
    v_mfma_f32_16x16x32_bf16 v[32:35], a[144:147], v[100:103], v[32:35]
    v_mfma_f32_16x16x32_bf16 v[36:39], a[148:151], v[100:103], v[36:39]
    buffer_load_dwordx4 v[92:95], v7, s[20:23], s51 offen sc1
    v_mfma_f32_16x16x32_bf16 v[40:43], a[152:155], v[100:103], v[40:43]
    v_mfma_f32_16x16x32_bf16 v[44:47], a[156:159], v[100:103], v[44:47]
    s_waitcnt vmcnt(11)
    v_mfma_f32_16x16x32_bf16 v[16:19], a[160:163], v[104:107], v[16:19]
    v_mfma_f32_16x16x32_bf16 v[20:23], a[164:167], v[104:107], v[20:23]
    s_mov_b32 s51, 2048
    buffer_load_dwordx4 v[96:99], v6, s[20:23], s51 offen sc1
    v_mfma_f32_16x16x32_bf16 v[24:27], a[168:171], v[104:107], v[24:27]
    v_mfma_f32_16x16x32_bf16 v[28:31], a[172:175], v[104:107], v[28:31]
    v_mfma_f32_16x16x32_bf16 v[32:35], a[160:163], v[108:111], v[32:35]
    v_mfma_f32_16x16x32_bf16 v[36:39], a[164:167], v[108:111], v[36:39]
    buffer_load_dwordx4 v[100:103], v7, s[20:23], s51 offen sc1
    v_mfma_f32_16x16x32_bf16 v[40:43], a[168:171], v[108:111], v[40:43]
    v_mfma_f32_16x16x32_bf16 v[44:47], a[172:175], v[108:111], v[44:47]
    s_waitcnt vmcnt(10)
    v_mfma_f32_16x16x32_bf16 v[16:19], a[176:179], v[112:115], v[16:19]
    v_mfma_f32_16x16x32_bf16 v[20:23], a[180:183], v[112:115], v[20:23]
    s_mov_b32 s51, 3072
    buffer_load_dwordx4 v[104:107], v6, s[20:23], s51 offen sc1
    v_mfma_f32_16x16x32_bf16 v[24:27], a[184:187], v[112:115], v[24:27]
    v_mfma_f32_16x16x32_bf16 v[28:31], a[188:191], v[112:115], v[28:31]
    v_mfma_f32_16x16x32_bf16 v[32:35], a[176:179], v[116:119], v[32:35]
    v_mfma_f32_16x16x32_bf16 v[36:39], a[180:183], v[116:119], v[36:39]
    buffer_load_dwordx4 v[108:111], v7, s[20:23], s51 offen sc1
    v_mfma_f32_16x16x32_bf16 v[40:43], a[184:187], v[116:119], v[40:43]
    v_mfma_f32_16x16x32_bf16 v[44:47], a[188:191], v[116:119], v[44:47]
    s_waitcnt vmcnt(10)
    v_mfma_f32_16x16x32_bf16 v[16:19], a[192:195], v[120:123], v[16:19]
    v_mfma_f32_16x16x32_bf16 v[20:23], a[196:199], v[120:123], v[20:23]
    s_mov_b32 s51, 4096
    buffer_load_dwordx4 v[112:115], v6, s[20:23], s51 offen sc1
    v_mfma_f32_16x16x32_bf16 v[24:27], a[200:203], v[120:123], v[24:27]
    v_mfma_f32_16x16x32_bf16 v[28:31], a[204:207], v[120:123], v[28:31]
    v_mfma_f32_16x16x32_bf16 v[32:35], a[192:195], v[124:127], v[32:35]
    v_mfma_f32_16x16x32_bf16 v[36:39], a[196:199], v[124:127], v[36:39]
    buffer_load_dwordx4 v[116:119], v7, s[20:23], s51 offen sc1
    v_mfma_f32_16x16x32_bf16 v[40:43], a[200:203], v[124:127], v[40:43]
    v_mfma_f32_16x16x32_bf16 v[44:47], a[204:207], v[124:127], v[44:47]
    s_waitcnt vmcnt(10)
    v_mfma_f32_16x16x32_bf16 v[16:19], a[208:211], v[128:131], v[16:19]
    v_mfma_f32_16x16x32_bf16 v[20:23], a[212:215], v[128:131], v[20:23]
    s_mov_b32 s51, 5120
    buffer_load_dwordx4 v[120:123], v6, s[20:23], s51 offen sc1
    v_mfma_f32_16x16x32_bf16 v[24:27], a[216:219], v[128:131], v[24:27]
    v_mfma_f32_16x16x32_bf16 v[28:31], a[220:223], v[128:131], v[28:31]
    v_mfma_f32_16x16x32_bf16 v[32:35], a[208:211], v[132:135], v[32:35]
    v_mfma_f32_16x16x32_bf16 v[36:39], a[212:215], v[132:135], v[36:39]
    buffer_load_dwordx4 v[124:127], v7, s[20:23], s51 offen sc1
    v_mfma_f32_16x16x32_bf16 v[40:43], a[216:219], v[132:135], v[40:43]
    v_mfma_f32_16x16x32_bf16 v[44:47], a[220:223], v[132:135], v[44:47]
    s_waitcnt vmcnt(10)
    v_mfma_f32_16x16x32_bf16 v[48:51], a[0:3], v[80:83], 0
    ds_write_b128 v190, v[16:19] offset:0
    v_mfma_f32_16x16x32_bf16 v[52:55], a[4:7], v[80:83], 0
    s_mov_b32 s51, 6144
    buffer_load_dwordx4 v[128:131], v6, s[20:23], s51 offen sc1
    v_mfma_f32_16x16x32_bf16 v[56:59], a[8:11], v[80:83], 0
    ds_write_b128 v190, v[20:23] offset:4096
    v_mfma_f32_16x16x32_bf16 v[60:63], a[12:15], v[80:83], 0
    ds_write_b128 v190, v[24:27] offset:8192
    v_mfma_f32_16x16x32_bf16 v[64:67], a[0:3], v[84:87], 0
    ds_write_b128 v190, v[28:31] offset:12288
    v_mfma_f32_16x16x32_bf16 v[68:71], a[4:7], v[84:87], 0
    buffer_load_dwordx4 v[132:135], v7, s[20:23], s51 offen sc1
    v_mfma_f32_16x16x32_bf16 v[72:75], a[8:11], v[84:87], 0
    ds_write_b128 v190, v[32:35] offset:16384
    v_mfma_f32_16x16x32_bf16 v[76:79], a[12:15], v[84:87], 0
    ds_write_b128 v190, v[36:39] offset:20480
    s_waitcnt vmcnt(10)
    v_mfma_f32_16x16x32_bf16 v[48:51], a[16:19], v[88:91], v[48:51]
    ds_write_b128 v190, v[40:43] offset:24576
    v_mfma_f32_16x16x32_bf16 v[52:55], a[20:23], v[88:91], v[52:55]
    s_mov_b32 s51, 7168
    buffer_load_dwordx4 v[80:83], v6, s[20:23], s51 offen sc1
    v_mfma_f32_16x16x32_bf16 v[56:59], a[24:27], v[88:91], v[56:59]
    ds_write_b128 v190, v[44:47] offset:28672
    v_mfma_f32_16x16x32_bf16 v[60:63], a[28:31], v[88:91], v[60:63]
    v_mfma_f32_16x16x32_bf16 v[64:67], a[16:19], v[92:95], v[64:67]
    v_mfma_f32_16x16x32_bf16 v[68:71], a[20:23], v[92:95], v[68:71]
    buffer_load_dwordx4 v[84:87], v7, s[20:23], s51 offen sc1
    v_mfma_f32_16x16x32_bf16 v[72:75], a[24:27], v[92:95], v[72:75]
    v_mfma_f32_16x16x32_bf16 v[76:79], a[28:31], v[92:95], v[76:79]
    s_waitcnt vmcnt(10)
    v_mfma_f32_16x16x32_bf16 v[48:51], a[32:35], v[96:99], v[48:51]
    v_mfma_f32_16x16x32_bf16 v[52:55], a[36:39], v[96:99], v[52:55]
    s_mov_b32 s51, 8192
    buffer_load_dwordx4 v[88:91], v6, s[20:23], s51 offen sc1
    v_mfma_f32_16x16x32_bf16 v[56:59], a[40:43], v[96:99], v[56:59]
    v_mfma_f32_16x16x32_bf16 v[60:63], a[44:47], v[96:99], v[60:63]
    v_mfma_f32_16x16x32_bf16 v[64:67], a[32:35], v[100:103], v[64:67]
    v_mfma_f32_16x16x32_bf16 v[68:71], a[36:39], v[100:103], v[68:71]
    buffer_load_dwordx4 v[92:95], v7, s[20:23], s51 offen sc1
    v_mfma_f32_16x16x32_bf16 v[72:75], a[40:43], v[100:103], v[72:75]
    v_mfma_f32_16x16x32_bf16 v[76:79], a[44:47], v[100:103], v[76:79]
    s_waitcnt lgkmcnt(0)
    s_barrier
    s_waitcnt vmcnt(10)
    v_mfma_f32_16x16x32_bf16 v[48:51], a[48:51], v[104:107], v[48:51]
    ds_read_b128 v[16:19], v191 offset:0
    v_mfma_f32_16x16x32_bf16 v[52:55], a[52:55], v[104:107], v[52:55]
    s_mov_b32 s51, 9216
    buffer_load_dwordx4 v[96:99], v6, s[20:23], s51 offen sc1
    v_mfma_f32_16x16x32_bf16 v[56:59], a[56:59], v[104:107], v[56:59]
    ds_read_b128 v[20:23], v191 offset:4096
    v_mfma_f32_16x16x32_bf16 v[60:63], a[60:63], v[104:107], v[60:63]
    ds_read_b128 v[24:27], v191 offset:1024
    v_mfma_f32_16x16x32_bf16 v[64:67], a[48:51], v[108:111], v[64:67]
    ds_read_b128 v[28:31], v191 offset:5120
    v_mfma_f32_16x16x32_bf16 v[68:71], a[52:55], v[108:111], v[68:71]
    buffer_load_dwordx4 v[100:103], v7, s[20:23], s51 offen sc1
    v_mfma_f32_16x16x32_bf16 v[72:75], a[56:59], v[108:111], v[72:75]
    ds_read_b128 v[32:35], v191 offset:2048
    v_mfma_f32_16x16x32_bf16 v[76:79], a[60:63], v[108:111], v[76:79]
    ds_read_b128 v[36:39], v191 offset:6144
    s_waitcnt vmcnt(10)
    v_mfma_f32_16x16x32_bf16 v[48:51], a[64:67], v[112:115], v[48:51]
    ds_read_b128 v[40:43], v191 offset:3072
    v_mfma_f32_16x16x32_bf16 v[52:55], a[68:71], v[112:115], v[52:55]
    s_mov_b32 s51, 10240
    buffer_load_dwordx4 v[104:107], v6, s[20:23], s51 offen sc1
    v_mfma_f32_16x16x32_bf16 v[56:59], a[72:75], v[112:115], v[56:59]
    ds_read_b128 v[44:47], v191 offset:7168
    v_mfma_f32_16x16x32_bf16 v[60:63], a[76:79], v[112:115], v[60:63]
    v_mfma_f32_16x16x32_bf16 v[64:67], a[64:67], v[116:119], v[64:67]
    v_mfma_f32_16x16x32_bf16 v[68:71], a[68:71], v[116:119], v[68:71]
    buffer_load_dwordx4 v[108:111], v7, s[20:23], s51 offen sc1
    v_mfma_f32_16x16x32_bf16 v[72:75], a[72:75], v[116:119], v[72:75]
    v_mfma_f32_16x16x32_bf16 v[76:79], a[76:79], v[116:119], v[76:79]
    s_waitcnt lgkmcnt(0)
    s_waitcnt vmcnt(10)
    v_mfma_f32_16x16x32_bf16 v[48:51], a[80:83], v[120:123], v[48:51]
    v_mul_f32 v180, v180, v180
    v_mfma_f32_16x16x32_bf16 v[52:55], a[84:87], v[120:123], v[52:55]
    s_mov_b32 s51, 11264
    buffer_load_dwordx4 v[112:115], v6, s[20:23], s51 offen sc1
    v_mfma_f32_16x16x32_bf16 v[56:59], a[88:91], v[120:123], v[56:59]
    v_pk_add_f32 v[16:17], v[16:17], v[24:25]
    v_mfma_f32_16x16x32_bf16 v[60:63], a[92:95], v[120:123], v[60:63]
    v_pk_add_f32 v[18:19], v[18:19], v[26:27]
    v_mfma_f32_16x16x32_bf16 v[64:67], a[80:83], v[124:127], v[64:67]
    v_pk_add_f32 v[20:21], v[20:21], v[28:29]
    v_mfma_f32_16x16x32_bf16 v[68:71], a[84:87], v[124:127], v[68:71]
    buffer_load_dwordx4 v[116:119], v7, s[20:23], s51 offen sc1
    v_mfma_f32_16x16x32_bf16 v[72:75], a[88:91], v[124:127], v[72:75]
    v_pk_add_f32 v[22:23], v[22:23], v[30:31]
    v_mfma_f32_16x16x32_bf16 v[76:79], a[92:95], v[124:127], v[76:79]
    v_pk_add_f32 v[32:33], v[32:33], v[40:41]
    s_waitcnt vmcnt(10)
    v_mfma_f32_16x16x32_bf16 v[48:51], a[96:99], v[128:131], v[48:51]
    v_pk_add_f32 v[34:35], v[34:35], v[42:43]
    v_mfma_f32_16x16x32_bf16 v[52:55], a[100:103], v[128:131], v[52:55]
    s_mov_b32 s51, 12288
    buffer_load_dwordx4 v[120:123], v6, s[20:23], s51 offen sc1
    v_mfma_f32_16x16x32_bf16 v[56:59], a[104:107], v[128:131], v[56:59]
    v_pk_add_f32 v[36:37], v[36:37], v[44:45]
    v_mfma_f32_16x16x32_bf16 v[60:63], a[108:111], v[128:131], v[60:63]
    v_pk_add_f32 v[38:39], v[38:39], v[46:47]
    v_mfma_f32_16x16x32_bf16 v[64:67], a[96:99], v[132:135], v[64:67]
    v_pk_add_f32 v[16:17], v[16:17], v[32:33]
    v_mfma_f32_16x16x32_bf16 v[68:71], a[100:103], v[132:135], v[68:71]
    buffer_load_dwordx4 v[124:127], v7, s[20:23], s51 offen sc1
    v_mfma_f32_16x16x32_bf16 v[72:75], a[104:107], v[132:135], v[72:75]
    v_pk_add_f32 v[18:19], v[18:19], v[34:35]
    v_mfma_f32_16x16x32_bf16 v[76:79], a[108:111], v[132:135], v[76:79]
    v_pk_add_f32 v[20:21], v[20:21], v[36:37]
    s_waitcnt vmcnt(10)
    v_mfma_f32_16x16x32_bf16 v[48:51], a[112:115], v[80:83], v[48:51]
    v_pk_add_f32 v[22:23], v[22:23], v[38:39]
    v_mfma_f32_16x16x32_bf16 v[52:55], a[116:119], v[80:83], v[52:55]
    s_mov_b32 s51, 13312
    buffer_load_dwordx4 v[128:131], v6, s[20:23], s51 offen sc1
    v_mfma_f32_16x16x32_bf16 v[56:59], a[120:123], v[80:83], v[56:59]
    v_lshlrev_b32 v196, 16, v176
    v_mfma_f32_16x16x32_bf16 v[60:63], a[124:127], v[80:83], v[60:63]
    v_and_b32 v197, 0xffff0000, v176
    v_mfma_f32_16x16x32_bf16 v[64:67], a[112:115], v[84:87], v[64:67]
    v_fmac_f32 v196, v180, v16
    v_mfma_f32_16x16x32_bf16 v[68:71], a[116:119], v[84:87], v[68:71]
    buffer_load_dwordx4 v[132:135], v7, s[20:23], s51 offen sc1
    v_mfma_f32_16x16x32_bf16 v[72:75], a[120:123], v[84:87], v[72:75]
    v_fmac_f32 v197, v180, v17
    v_mfma_f32_16x16x32_bf16 v[76:79], a[124:127], v[84:87], v[76:79]
    v_cvt_pk_bf16_f32 v192, v196, v197
    s_waitcnt vmcnt(10)
    v_mfma_f32_16x16x32_bf16 v[48:51], a[128:131], v[88:91], v[48:51]
    v_lshlrev_b32 v196, 16, v177
    v_mfma_f32_16x16x32_bf16 v[52:55], a[132:135], v[88:91], v[52:55]
    v_mfma_f32_16x16x32_bf16 v[56:59], a[136:139], v[88:91], v[56:59]
    v_and_b32 v197, 0xffff0000, v177
    v_mfma_f32_16x16x32_bf16 v[60:63], a[140:143], v[88:91], v[60:63]
    v_fmac_f32 v196, v180, v18
    v_mfma_f32_16x16x32_bf16 v[64:67], a[128:131], v[92:95], v[64:67]
    v_fmac_f32 v197, v180, v19
    v_mfma_f32_16x16x32_bf16 v[68:71], a[132:135], v[92:95], v[68:71]
    v_mfma_f32_16x16x32_bf16 v[72:75], a[136:139], v[92:95], v[72:75]
    v_cvt_pk_bf16_f32 v193, v196, v197
    v_mfma_f32_16x16x32_bf16 v[76:79], a[140:143], v[92:95], v[76:79]
    v_lshlrev_b32 v196, 16, v178
    s_waitcnt vmcnt(8)
    v_mfma_f32_16x16x32_bf16 v[48:51], a[144:147], v[96:99], v[48:51]
    v_and_b32 v197, 0xffff0000, v178
    v_mfma_f32_16x16x32_bf16 v[52:55], a[148:151], v[96:99], v[52:55]
    v_mfma_f32_16x16x32_bf16 v[56:59], a[152:155], v[96:99], v[56:59]
    v_fmac_f32 v196, v180, v20
    v_mfma_f32_16x16x32_bf16 v[60:63], a[156:159], v[96:99], v[60:63]
    v_fmac_f32 v197, v180, v21
    v_mfma_f32_16x16x32_bf16 v[64:67], a[144:147], v[100:103], v[64:67]
    v_cvt_pk_bf16_f32 v194, v196, v197
    v_mfma_f32_16x16x32_bf16 v[68:71], a[148:151], v[100:103], v[68:71]
    v_mfma_f32_16x16x32_bf16 v[72:75], a[152:155], v[100:103], v[72:75]
    v_lshlrev_b32 v196, 16, v179
    v_mfma_f32_16x16x32_bf16 v[76:79], a[156:159], v[100:103], v[76:79]
    v_and_b32 v197, 0xffff0000, v179
    s_waitcnt vmcnt(6)
    v_mfma_f32_16x16x32_bf16 v[48:51], a[160:163], v[104:107], v[48:51]
    v_fmac_f32 v196, v180, v22
    v_mfma_f32_16x16x32_bf16 v[52:55], a[164:167], v[104:107], v[52:55]
    v_mfma_f32_16x16x32_bf16 v[56:59], a[168:171], v[104:107], v[56:59]
    v_fmac_f32 v197, v180, v23
    v_mfma_f32_16x16x32_bf16 v[60:63], a[172:175], v[104:107], v[60:63]
    v_cvt_pk_bf16_f32 v195, v196, v197
    v_mfma_f32_16x16x32_bf16 v[64:67], a[160:163], v[108:111], v[64:67]
    v_permlane16_swap_b32 v192, v194
    v_mfma_f32_16x16x32_bf16 v[68:71], a[164:167], v[108:111], v[68:71]
    v_mfma_f32_16x16x32_bf16 v[72:75], a[168:171], v[108:111], v[72:75]
    v_permlane16_swap_b32 v193, v195
    v_mfma_f32_16x16x32_bf16 v[76:79], a[172:175], v[108:111], v[76:79]
    s_waitcnt vmcnt(4)
    v_mfma_f32_16x16x32_bf16 v[48:51], a[176:179], v[112:115], v[48:51]
    v_mfma_f32_16x16x32_bf16 v[52:55], a[180:183], v[112:115], v[52:55]
    v_mfma_f32_16x16x32_bf16 v[56:59], a[184:187], v[112:115], v[56:59]
    v_mfma_f32_16x16x32_bf16 v[60:63], a[188:191], v[112:115], v[60:63]
    v_mfma_f32_16x16x32_bf16 v[64:67], a[176:179], v[116:119], v[64:67]
    v_mfma_f32_16x16x32_bf16 v[68:71], a[180:183], v[116:119], v[68:71]
    v_mfma_f32_16x16x32_bf16 v[72:75], a[184:187], v[116:119], v[72:75]
    v_mfma_f32_16x16x32_bf16 v[76:79], a[188:191], v[116:119], v[76:79]
    buffer_store_dwordx4 v[192:195], v11, s[28:31], 0 offen sc1
    s_waitcnt vmcnt(3)
    v_mfma_f32_16x16x32_bf16 v[48:51], a[192:195], v[120:123], v[48:51]
    v_mfma_f32_16x16x32_bf16 v[52:55], a[196:199], v[120:123], v[52:55]
    v_mfma_f32_16x16x32_bf16 v[56:59], a[200:203], v[120:123], v[56:59]
    v_mfma_f32_16x16x32_bf16 v[60:63], a[204:207], v[120:123], v[60:63]
    v_mfma_f32_16x16x32_bf16 v[64:67], a[192:195], v[124:127], v[64:67]
    v_mfma_f32_16x16x32_bf16 v[68:71], a[196:199], v[124:127], v[68:71]
    v_mfma_f32_16x16x32_bf16 v[72:75], a[200:203], v[124:127], v[72:75]
    v_mfma_f32_16x16x32_bf16 v[76:79], a[204:207], v[124:127], v[76:79]
    s_waitcnt vmcnt(1)
    v_mfma_f32_16x16x32_bf16 v[48:51], a[208:211], v[128:131], v[48:51]
    v_mfma_f32_16x16x32_bf16 v[52:55], a[212:215], v[128:131], v[52:55]
    v_mfma_f32_16x16x32_bf16 v[56:59], a[216:219], v[128:131], v[56:59]
    v_mfma_f32_16x16x32_bf16 v[60:63], a[220:223], v[128:131], v[60:63]
    v_mfma_f32_16x16x32_bf16 v[64:67], a[208:211], v[132:135], v[64:67]
    v_mfma_f32_16x16x32_bf16 v[68:71], a[212:215], v[132:135], v[68:71]
    v_mfma_f32_16x16x32_bf16 v[72:75], a[216:219], v[132:135], v[72:75]
    v_mfma_f32_16x16x32_bf16 v[76:79], a[220:223], v[132:135], v[76:79]
    s_nop 0
    ds_write_b128 v190, v[48:51] offset:32768
    ds_write_b128 v190, v[52:55] offset:36864
    ds_write_b128 v190, v[56:59] offset:40960
    ds_write_b128 v190, v[60:63] offset:45056
    ds_write_b128 v190, v[64:67] offset:49152
    ds_write_b128 v190, v[68:71] offset:53248
    ds_write_b128 v190, v[72:75] offset:57344
    ds_write_b128 v190, v[76:79] offset:61440
    s_waitcnt lgkmcnt(0)
    s_barrier
    ds_read_b128 v[16:19], v191 offset:32768
    ds_read_b128 v[20:23], v191 offset:36864
    ds_read_b128 v[24:27], v191 offset:33792
    ds_read_b128 v[28:31], v191 offset:37888
    ds_read_b128 v[32:35], v191 offset:34816
    ds_read_b128 v[36:39], v191 offset:38912
    ds_read_b128 v[40:43], v191 offset:35840
    ds_read_b128 v[44:47], v191 offset:39936
    s_waitcnt lgkmcnt(0)
    v_mul_f32 v188, v188, v188
    v_pk_add_f32 v[16:17], v[16:17], v[24:25]
    v_pk_add_f32 v[18:19], v[18:19], v[26:27]
    v_pk_add_f32 v[20:21], v[20:21], v[28:29]
    v_pk_add_f32 v[22:23], v[22:23], v[30:31]
    v_pk_add_f32 v[32:33], v[32:33], v[40:41]
    v_pk_add_f32 v[34:35], v[34:35], v[42:43]
    v_pk_add_f32 v[36:37], v[36:37], v[44:45]
    v_pk_add_f32 v[38:39], v[38:39], v[46:47]
    v_pk_add_f32 v[16:17], v[16:17], v[32:33]
    v_pk_add_f32 v[18:19], v[18:19], v[34:35]
    v_pk_add_f32 v[20:21], v[20:21], v[36:37]
    v_pk_add_f32 v[22:23], v[22:23], v[38:39]
    v_lshlrev_b32 v196, 16, v184
    v_and_b32 v197, 0xffff0000, v184
    v_fmac_f32 v196, v188, v16
    v_fmac_f32 v197, v188, v17
    v_cvt_pk_bf16_f32 v192, v196, v197
    v_lshlrev_b32 v196, 16, v185
    v_and_b32 v197, 0xffff0000, v185
    v_fmac_f32 v196, v188, v18
    v_fmac_f32 v197, v188, v19
    v_cvt_pk_bf16_f32 v193, v196, v197
    v_lshlrev_b32 v196, 16, v186
    v_and_b32 v197, 0xffff0000, v186
    v_fmac_f32 v196, v188, v20
    v_fmac_f32 v197, v188, v21
    v_cvt_pk_bf16_f32 v194, v196, v197
    v_lshlrev_b32 v196, 16, v187
    v_and_b32 v197, 0xffff0000, v187
    v_fmac_f32 v196, v188, v22
    v_fmac_f32 v197, v188, v23
    v_cvt_pk_bf16_f32 v195, v196, v197
    v_permlane16_swap_b32 v192, v194
    s_nop 0
    v_permlane16_swap_b32 v193, v195
    buffer_store_dwordx4 v[192:195], v11, s[28:31], s55 offen sc1
    s_endpgm
g_stats:
    s_lshl_b32 s45, s47, 4
    s_lshl_b32 s49, s48, 2
    s_add_u32 s45, s45, s49
    s_add_u32 s45, s45, s44
    s_lshl_b32 s49, s45, 14
    s_waitcnt lgkmcnt(0)
    s_add_u32 s50, s49, 4194304
    s_add_u32 s20, s12, s50
    s_addc_u32 s21, s13, 0
    s_mov_b32 s22, 16384
    s_mov_b32 s23, 131072
    s_mov_b32 s53, 4096
    s_mov_b32 s54, 8192
    s_mov_b32 s55, 12288
    s_add_u32 s14, s12, 6488064
    s_addc_u32 s15, s13, 0
    buffer_load_dwordx4 v[32:35], v2, s[20:23], 0 offen offset:0
    buffer_load_dwordx4 v[36:39], v2, s[20:23], 0 offen offset:1024
    buffer_load_dwordx4 v[40:43], v2, s[20:23], 0 offen offset:2048
    buffer_load_dwordx4 v[44:47], v2, s[20:23], 0 offen offset:3072
    buffer_load_dwordx4 v[48:51], v2, s[20:23], s53 offen offset:0
    buffer_load_dwordx4 v[52:55], v2, s[20:23], s53 offen offset:1024
    buffer_load_dwordx4 v[56:59], v2, s[20:23], s53 offen offset:2048
    buffer_load_dwordx4 v[60:63], v2, s[20:23], s53 offen offset:3072
    buffer_load_dwordx4 v[64:67], v2, s[20:23], s54 offen offset:0
    buffer_load_dwordx4 v[68:71], v2, s[20:23], s54 offen offset:1024
    buffer_load_dwordx4 v[72:75], v2, s[20:23], s54 offen offset:2048
    buffer_load_dwordx4 v[76:79], v2, s[20:23], s54 offen offset:3072
    buffer_load_dwordx4 v[80:83], v2, s[20:23], s55 offen offset:0
    buffer_load_dwordx4 v[84:87], v2, s[20:23], s55 offen offset:1024
    buffer_load_dwordx4 v[88:91], v2, s[20:23], s55 offen offset:2048
    buffer_load_dwordx4 v[92:95], v2, s[20:23], s55 offen offset:3072
    v_bfe_u32 v8, v1, 4, 2
    v_lshlrev_b32 v8, 1, v8
    v_and_b32 v3, 7, v1
    v_xor_b32 v3, v3, v8
    v_lshlrev_b32 v3, 4, v3
    v_lshrrev_b32 v8, 3, v1
    v_mul_u32_u24 v8, 3584, v8
    v_add_u32 v3, v3, v8
    s_mul_i32 s50, s44, 458752
    v_add_u32 v3, s50, v3
    s_lshl_b32 s56, s44, 14
    s_add_u32 s60, s2, 0
    s_cmp_ge_u32 s60, 28
    s_cselect_b32 s61, 1, 0
    s_mul_i32 s62, s61, 28
    s_sub_u32 s62, s60, s62
    s_cmp_eq_u32 s61, 0
    s_cselect_b32 s24, s4, s6
    s_cselect_b32 s25, s5, s7
    s_mov_b32 s26, 1835008
    s_mov_b32 s27, 131072
    s_cmp_ge_u32 s60, 56
    s_cselect_b32 s26, 0, s26
    s_lshl_b32 s57, s62, 7
    s_mul_i32 s63, s61, 7168
    s_lshl_b32 s62, s62, 8
    s_add_u32 s63, s63, s62
    s_cmp_ge_u32 s60, 56
    s_cselect_b32 s63, 0x80000000, s63
    s_add_u32 m0, s56, 0
    s_nop 0
    buffer_load_dwordx4 v3, s[24:27], s57 offen lds
    s_add_u32 m0, s56, 1024
    s_add_u32 s57, s57, 28672
    buffer_load_dwordx4 v3, s[24:27], s57 offen lds
    s_add_u32 m0, s56, 2048
    s_add_u32 s57, s57, 28672
    buffer_load_dwordx4 v3, s[24:27], s57 offen lds
    s_add_u32 m0, s56, 3072
    s_add_u32 s57, s57, 28672
    buffer_load_dwordx4 v3, s[24:27], s57 offen lds
    s_add_u32 m0, s56, 4096
    s_add_u32 s57, s57, 28672
    buffer_load_dwordx4 v3, s[24:27], s57 offen lds
    s_add_u32 m0, s56, 5120
    s_add_u32 s57, s57, 28672
    buffer_load_dwordx4 v3, s[24:27], s57 offen lds
    s_add_u32 m0, s56, 6144
    s_add_u32 s57, s57, 28672
    buffer_load_dwordx4 v3, s[24:27], s57 offen lds
    s_add_u32 m0, s56, 7168
    s_add_u32 s57, s57, 28672
    buffer_load_dwordx4 v3, s[24:27], s57 offen lds
    s_add_u32 m0, s56, 8192
    s_add_u32 s57, s57, 28672
    buffer_load_dwordx4 v3, s[24:27], s57 offen lds
    s_add_u32 m0, s56, 9216
    s_add_u32 s57, s57, 28672
    buffer_load_dwordx4 v3, s[24:27], s57 offen lds
    s_add_u32 m0, s56, 10240
    s_add_u32 s57, s57, 28672
    buffer_load_dwordx4 v3, s[24:27], s57 offen lds
    s_add_u32 m0, s56, 11264
    s_add_u32 s57, s57, 28672
    buffer_load_dwordx4 v3, s[24:27], s57 offen lds
    s_add_u32 m0, s56, 12288
    s_add_u32 s57, s57, 28672
    buffer_load_dwordx4 v3, s[24:27], s57 offen lds
    s_add_u32 m0, s56, 13312
    s_add_u32 s57, s57, 28672
    buffer_load_dwordx4 v3, s[24:27], s57 offen lds
    s_add_u32 m0, s56, 14336
    s_add_u32 s57, s57, 28672
    buffer_load_dwordx4 v3, s[24:27], s57 offen lds
    s_add_u32 m0, s56, 15360
    s_add_u32 s57, s57, 28672
    buffer_load_dwordx4 v3, s[24:27], s57 offen lds
    s_add_u32 s60, s2, 32
    s_cmp_ge_u32 s60, 28
    s_cselect_b32 s61, 1, 0
    s_mul_i32 s62, s61, 28
    s_sub_u32 s62, s60, s62
    s_cmp_eq_u32 s61, 0
    s_cselect_b32 s24, s4, s6
    s_cselect_b32 s25, s5, s7
    s_mov_b32 s26, 1835008
    s_mov_b32 s27, 131072
    s_cmp_ge_u32 s60, 56
    s_cselect_b32 s26, 0, s26
    s_lshl_b32 s57, s62, 7
    s_mul_i32 s64, s61, 7168
    s_lshl_b32 s62, s62, 8
    s_add_u32 s64, s64, s62
    s_cmp_ge_u32 s60, 56
    s_cselect_b32 s64, 0x80000000, s64
    s_add_u32 m0, s56, 65536
    s_nop 0
    buffer_load_dwordx4 v3, s[24:27], s57 offen lds
    s_add_u32 m0, s56, 66560
    s_add_u32 s57, s57, 28672
    buffer_load_dwordx4 v3, s[24:27], s57 offen lds
    s_add_u32 m0, s56, 67584
    s_add_u32 s57, s57, 28672
    buffer_load_dwordx4 v3, s[24:27], s57 offen lds
    s_add_u32 m0, s56, 68608
    s_add_u32 s57, s57, 28672
    buffer_load_dwordx4 v3, s[24:27], s57 offen lds
    s_add_u32 m0, s56, 69632
    s_add_u32 s57, s57, 28672
    buffer_load_dwordx4 v3, s[24:27], s57 offen lds
    s_add_u32 m0, s56, 70656
    s_add_u32 s57, s57, 28672
    buffer_load_dwordx4 v3, s[24:27], s57 offen lds
    s_add_u32 m0, s56, 71680
    s_add_u32 s57, s57, 28672
    buffer_load_dwordx4 v3, s[24:27], s57 offen lds
    s_add_u32 m0, s56, 72704
    s_add_u32 s57, s57, 28672
    buffer_load_dwordx4 v3, s[24:27], s57 offen lds
    s_add_u32 m0, s56, 73728
    s_add_u32 s57, s57, 28672
    buffer_load_dwordx4 v3, s[24:27], s57 offen lds
    s_add_u32 m0, s56, 74752
    s_add_u32 s57, s57, 28672
    buffer_load_dwordx4 v3, s[24:27], s57 offen lds
    s_add_u32 m0, s56, 75776
    s_add_u32 s57, s57, 28672
    buffer_load_dwordx4 v3, s[24:27], s57 offen lds
    s_add_u32 m0, s56, 76800
    s_add_u32 s57, s57, 28672
    buffer_load_dwordx4 v3, s[24:27], s57 offen lds
    s_add_u32 m0, s56, 77824
    s_add_u32 s57, s57, 28672
    buffer_load_dwordx4 v3, s[24:27], s57 offen lds
    s_add_u32 m0, s56, 78848
    s_add_u32 s57, s57, 28672
    buffer_load_dwordx4 v3, s[24:27], s57 offen lds
    s_add_u32 m0, s56, 79872
    s_add_u32 s57, s57, 28672
    buffer_load_dwordx4 v3, s[24:27], s57 offen lds
    s_add_u32 m0, s56, 80896
    s_add_u32 s57, s57, 28672
    buffer_load_dwordx4 v3, s[24:27], s57 offen lds
    s_add_u32 s36, s12, 6422528
    s_addc_u32 s37, s13, 0
    s_mov_b32 s38, 16384
    s_mov_b32 s39, 131072
    v_mov_b32 v16, 0
    v_mov_b32 v17, 0
    v_mov_b32 v18, 0
    v_mov_b32 v19, 0
    v_mov_b32 v20, 0
    v_mov_b32 v21, 0
    v_mov_b32 v22, 0
    v_mov_b32 v23, 0
    v_mov_b32 v24, 0x3f803f80
    v_mov_b32 v25, 0x3f803f80
    v_mov_b32 v26, 0x3f803f80
    v_mov_b32 v27, 0x3f803f80
    s_waitcnt vmcnt(47)
    s_nop 0
    v_mfma_f32_16x16x32_bf16 v[16:19], v[24:27], v[32:35], v[16:19]
    v_mfma_f32_16x16x32_bf16 v[20:23], v[32:35], v[32:35], v[20:23]
    s_waitcnt vmcnt(46)
    v_mfma_f32_16x16x32_bf16 v[16:19], v[24:27], v[36:39], v[16:19]
    v_mfma_f32_16x16x32_bf16 v[20:23], v[36:39], v[36:39], v[20:23]
    s_waitcnt vmcnt(45)
    v_mfma_f32_16x16x32_bf16 v[16:19], v[24:27], v[40:43], v[16:19]
    v_mfma_f32_16x16x32_bf16 v[20:23], v[40:43], v[40:43], v[20:23]
    s_waitcnt vmcnt(44)
    v_mfma_f32_16x16x32_bf16 v[16:19], v[24:27], v[44:47], v[16:19]
    v_mfma_f32_16x16x32_bf16 v[20:23], v[44:47], v[44:47], v[20:23]
    s_waitcnt vmcnt(43)
    v_mfma_f32_16x16x32_bf16 v[16:19], v[24:27], v[48:51], v[16:19]
    v_mfma_f32_16x16x32_bf16 v[20:23], v[48:51], v[48:51], v[20:23]
    s_waitcnt vmcnt(42)
    v_mfma_f32_16x16x32_bf16 v[16:19], v[24:27], v[52:55], v[16:19]
    v_mfma_f32_16x16x32_bf16 v[20:23], v[52:55], v[52:55], v[20:23]
    s_waitcnt vmcnt(41)
    v_mfma_f32_16x16x32_bf16 v[16:19], v[24:27], v[56:59], v[16:19]
    v_mfma_f32_16x16x32_bf16 v[20:23], v[56:59], v[56:59], v[20:23]
    s_waitcnt vmcnt(40)
    v_mfma_f32_16x16x32_bf16 v[16:19], v[24:27], v[60:63], v[16:19]
    v_mfma_f32_16x16x32_bf16 v[20:23], v[60:63], v[60:63], v[20:23]
    s_waitcnt vmcnt(39)
    v_mfma_f32_16x16x32_bf16 v[16:19], v[24:27], v[64:67], v[16:19]
    v_mfma_f32_16x16x32_bf16 v[20:23], v[64:67], v[64:67], v[20:23]
    s_waitcnt vmcnt(38)
    v_mfma_f32_16x16x32_bf16 v[16:19], v[24:27], v[68:71], v[16:19]
    v_mfma_f32_16x16x32_bf16 v[20:23], v[68:71], v[68:71], v[20:23]
    s_waitcnt vmcnt(37)
    v_mfma_f32_16x16x32_bf16 v[16:19], v[24:27], v[72:75], v[16:19]
    v_mfma_f32_16x16x32_bf16 v[20:23], v[72:75], v[72:75], v[20:23]
    s_waitcnt vmcnt(36)
    v_mfma_f32_16x16x32_bf16 v[16:19], v[24:27], v[76:79], v[16:19]
    v_mfma_f32_16x16x32_bf16 v[20:23], v[76:79], v[76:79], v[20:23]
    s_waitcnt vmcnt(35)
    v_mfma_f32_16x16x32_bf16 v[16:19], v[24:27], v[80:83], v[16:19]
    v_mfma_f32_16x16x32_bf16 v[20:23], v[80:83], v[80:83], v[20:23]
    s_waitcnt vmcnt(34)
    v_mfma_f32_16x16x32_bf16 v[16:19], v[24:27], v[84:87], v[16:19]
    v_mfma_f32_16x16x32_bf16 v[20:23], v[84:87], v[84:87], v[20:23]
    s_waitcnt vmcnt(33)
    v_mfma_f32_16x16x32_bf16 v[16:19], v[24:27], v[88:91], v[16:19]
    v_mfma_f32_16x16x32_bf16 v[20:23], v[88:91], v[88:91], v[20:23]
    s_waitcnt vmcnt(32)
    v_mfma_f32_16x16x32_bf16 v[16:19], v[24:27], v[92:95], v[16:19]
    v_mfma_f32_16x16x32_bf16 v[20:23], v[92:95], v[92:95], v[20:23]
    v_mov_b32 v104, s63
    v_mov_b32 v105, s64
    v_and_b32 v8, 15, v1
    v_lshrrev_b32 v9, 2, v8
    v_lshl_add_u32 v9, v9, 4, v8
    v_lshlrev_b32 v9, 2, v9
    v_and_b32 v8, 3, v1
    v_cmp_eq_u32 s[60:61], 1, v8
    v_cmp_eq_u32 s[62:63], 2, v8
    v_cmp_eq_u32 s[64:65], 3, v8
    v_cndmask_b32 v10, v20, v21, s[60:61]
    v_cndmask_b32 v10, v10, v22, s[62:63]
    v_cndmask_b32 v10, v10, v23, s[64:65]
    ds_bpermute_b32 v10, v9, v10
    v_mul_f32 v12, 0x3b000000, v16
    v_mul_f32 v8, v12, v12
    s_mov_b32 s66, 0x3b000000
    s_waitcnt lgkmcnt(0)
    v_fma_f32 v8, v10, s66, -v8
    v_max_f32 v8, 0, v8
    v_add_f32 v8, 0x3727c5ac, v8
    v_rsq_f32 v13, v8
    v_and_b32 v8, 15, v1
    v_lshlrev_b32 v8, 3, v8
    s_lshl_b32 s50, s45, 7
    v_add_u32 v8, s50, v8
    s_mov_b64 exec, 0xffff
    buffer_store_dwordx2 v[12:13], v8, s[36:39], 0 offen sc1
    s_mov_b64 exec, -1
    v_bfe_u32 v8, v1, 2, 2
    v_lshrrev_b32 v9, 4, v1
    v_lshl_add_u32 v8, v9, 2, v8
    v_bfe_u32 v10, v8, 1, 2
    v_lshlrev_b32 v10, 1, v10
    v_lshlrev_b32 v8, 7, v8
    v_and_b32 v11, 1, v1
    v_lshl_add_u32 v8, v11, 3, v8
    v_bfe_u32 v11, v1, 1, 1
    v_xor_b32 v10, v10, v11
    s_lshl_b32 s50, s44, 1
    v_xor_b32 v10, s50, v10
    v_lshl_add_u32 v100, v10, 4, v8
    v_add_u32 v101, 65536, v100
    s_lshl_b32 s50, s44, 6
    v_lshl_add_u32 v102, v9, 4, s50
    s_add_u32 s28, s12, 6356992
    s_addc_u32 s29, s13, 0
    s_mov_b32 s30, 14336
    s_mov_b32 s31, 131072
    s_waitcnt vmcnt(1)
    s_barrier
    ds_read_b64_tr_b16 v[32:33], v100 offset:0
    ds_read_b64_tr_b16 v[34:35], v100 offset:2048
    ds_read_b64_tr_b16 v[36:37], v100 offset:4096
    ds_read_b64_tr_b16 v[38:39], v100 offset:6144
    ds_read_b64_tr_b16 v[40:41], v100 offset:8192
    ds_read_b64_tr_b16 v[42:43], v100 offset:10240
    ds_read_b64_tr_b16 v[44:45], v100 offset:12288
    ds_read_b64_tr_b16 v[46:47], v100 offset:14336
    s_waitcnt lgkmcnt(4)
    ds_read_b64_tr_b16 v[48:49], v100 offset:16384
    ds_read_b64_tr_b16 v[50:51], v100 offset:18432
    ds_read_b64_tr_b16 v[52:53], v100 offset:20480
    ds_read_b64_tr_b16 v[54:55], v100 offset:22528
    ds_read_b64_tr_b16 v[56:57], v100 offset:24576
    ds_read_b64_tr_b16 v[58:59], v100 offset:26624
    ds_read_b64_tr_b16 v[60:61], v100 offset:28672
    ds_read_b64_tr_b16 v[62:63], v100 offset:30720
    s_waitcnt lgkmcnt(4)
    ds_read_b64_tr_b16 v[64:65], v100 offset:32768
    ds_read_b64_tr_b16 v[66:67], v100 offset:34816
    ds_read_b64_tr_b16 v[68:69], v100 offset:36864
    ds_read_b64_tr_b16 v[70:71], v100 offset:38912
    ds_read_b64_tr_b16 v[72:73], v100 offset:40960
    ds_read_b64_tr_b16 v[74:75], v100 offset:43008
    ds_read_b64_tr_b16 v[76:77], v100 offset:45056
    ds_read_b64_tr_b16 v[78:79], v100 offset:47104
    s_waitcnt lgkmcnt(4)
    ds_read_b64_tr_b16 v[80:81], v100 offset:49152
    ds_read_b64_tr_b16 v[82:83], v100 offset:51200
    ds_read_b64_tr_b16 v[84:85], v100 offset:53248
    ds_read_b64_tr_b16 v[86:87], v100 offset:55296
    ds_read_b64_tr_b16 v[88:89], v100 offset:57344
    ds_read_b64_tr_b16 v[90:91], v100 offset:59392
    ds_read_b64_tr_b16 v[92:93], v100 offset:61440
    ds_read_b64_tr_b16 v[94:95], v100 offset:63488
    s_waitcnt lgkmcnt(0)
    v_mfma_f32_16x16x32_bf16 v[108:111], v[32:35], v[24:27], 0
    v_mfma_f32_16x16x32_bf16 v[108:111], v[36:39], v[24:27], v[108:111]
    v_mfma_f32_16x16x32_bf16 v[108:111], v[40:43], v[24:27], v[108:111]
    v_mfma_f32_16x16x32_bf16 v[108:111], v[44:47], v[24:27], v[108:111]
    v_mfma_f32_16x16x32_bf16 v[108:111], v[48:51], v[24:27], v[108:111]
    v_mfma_f32_16x16x32_bf16 v[108:111], v[52:55], v[24:27], v[108:111]
    v_mfma_f32_16x16x32_bf16 v[108:111], v[56:59], v[24:27], v[108:111]
    v_mfma_f32_16x16x32_bf16 v[108:111], v[60:63], v[24:27], v[108:111]
    v_mfma_f32_16x16x32_bf16 v[108:111], v[64:67], v[24:27], v[108:111]
    v_mfma_f32_16x16x32_bf16 v[108:111], v[68:71], v[24:27], v[108:111]
    v_mfma_f32_16x16x32_bf16 v[108:111], v[72:75], v[24:27], v[108:111]
    v_mfma_f32_16x16x32_bf16 v[108:111], v[76:79], v[24:27], v[108:111]
    v_mfma_f32_16x16x32_bf16 v[108:111], v[80:83], v[24:27], v[108:111]
    v_mfma_f32_16x16x32_bf16 v[108:111], v[84:87], v[24:27], v[108:111]
    v_mfma_f32_16x16x32_bf16 v[108:111], v[88:91], v[24:27], v[108:111]
    v_mfma_f32_16x16x32_bf16 v[108:111], v[92:95], v[24:27], v[108:111]
    ds_read_b64_tr_b16 v[32:33], v101 offset:0
    ds_read_b64_tr_b16 v[34:35], v101 offset:2048
    ds_read_b64_tr_b16 v[36:37], v101 offset:4096
    ds_read_b64_tr_b16 v[38:39], v101 offset:6144
    ds_read_b64_tr_b16 v[40:41], v101 offset:8192
    ds_read_b64_tr_b16 v[42:43], v101 offset:10240
    ds_read_b64_tr_b16 v[44:45], v101 offset:12288
    ds_read_b64_tr_b16 v[46:47], v101 offset:14336
    s_waitcnt lgkmcnt(4)
    ds_read_b64_tr_b16 v[48:49], v101 offset:16384
    ds_read_b64_tr_b16 v[50:51], v101 offset:18432
    ds_read_b64_tr_b16 v[52:53], v101 offset:20480
    ds_read_b64_tr_b16 v[54:55], v101 offset:22528
    ds_read_b64_tr_b16 v[56:57], v101 offset:24576
    ds_read_b64_tr_b16 v[58:59], v101 offset:26624
    ds_read_b64_tr_b16 v[60:61], v101 offset:28672
    ds_read_b64_tr_b16 v[62:63], v101 offset:30720
    s_waitcnt lgkmcnt(4)
    ds_read_b64_tr_b16 v[64:65], v101 offset:32768
    ds_read_b64_tr_b16 v[66:67], v101 offset:34816
    ds_read_b64_tr_b16 v[68:69], v101 offset:36864
    ds_read_b64_tr_b16 v[70:71], v101 offset:38912
    ds_read_b64_tr_b16 v[72:73], v101 offset:40960
    ds_read_b64_tr_b16 v[74:75], v101 offset:43008
    ds_read_b64_tr_b16 v[76:77], v101 offset:45056
    ds_read_b64_tr_b16 v[78:79], v101 offset:47104
    s_waitcnt lgkmcnt(4)
    ds_read_b64_tr_b16 v[80:81], v101 offset:49152
    ds_read_b64_tr_b16 v[82:83], v101 offset:51200
    ds_read_b64_tr_b16 v[84:85], v101 offset:53248
    ds_read_b64_tr_b16 v[86:87], v101 offset:55296
    ds_read_b64_tr_b16 v[88:89], v101 offset:57344
    ds_read_b64_tr_b16 v[90:91], v101 offset:59392
    ds_read_b64_tr_b16 v[92:93], v101 offset:61440
    ds_read_b64_tr_b16 v[94:95], v101 offset:63488
    s_waitcnt lgkmcnt(0)
    v_mfma_f32_16x16x32_bf16 v[112:115], v[32:35], v[24:27], 0
    v_mfma_f32_16x16x32_bf16 v[112:115], v[36:39], v[24:27], v[112:115]
    v_mfma_f32_16x16x32_bf16 v[112:115], v[40:43], v[24:27], v[112:115]
    v_mfma_f32_16x16x32_bf16 v[112:115], v[44:47], v[24:27], v[112:115]
    v_mfma_f32_16x16x32_bf16 v[112:115], v[48:51], v[24:27], v[112:115]
    v_mfma_f32_16x16x32_bf16 v[112:115], v[52:55], v[24:27], v[112:115]
    v_mfma_f32_16x16x32_bf16 v[112:115], v[56:59], v[24:27], v[112:115]
    v_mfma_f32_16x16x32_bf16 v[112:115], v[60:63], v[24:27], v[112:115]
    v_mfma_f32_16x16x32_bf16 v[112:115], v[64:67], v[24:27], v[112:115]
    v_mfma_f32_16x16x32_bf16 v[112:115], v[68:71], v[24:27], v[112:115]
    v_mfma_f32_16x16x32_bf16 v[112:115], v[72:75], v[24:27], v[112:115]
    v_mfma_f32_16x16x32_bf16 v[112:115], v[76:79], v[24:27], v[112:115]
    v_mfma_f32_16x16x32_bf16 v[112:115], v[80:83], v[24:27], v[112:115]
    v_mfma_f32_16x16x32_bf16 v[112:115], v[84:87], v[24:27], v[112:115]
    v_mfma_f32_16x16x32_bf16 v[112:115], v[88:91], v[24:27], v[112:115]
    v_mfma_f32_16x16x32_bf16 v[112:115], v[92:95], v[24:27], v[112:115]
    v_add_u32 v104, v104, v102
    v_add_u32 v105, v105, v102
    v_and_b32 v8, 15, v1
    v_cmp_eq_u32 vcc, 0, v8
    s_nop 0
    s_and_saveexec_b64 s[50:51], vcc
    buffer_store_dwordx4 v[108:111], v104, s[28:31], 0 offen sc1
    s_nop 0
    buffer_store_dwordx4 v[112:115], v105, s[28:31], 0 offen sc1
    s_mov_b64 exec, -1
    s_waitcnt vmcnt(0)
    s_barrier
    s_cmp_lg_u32 s44, 0
    s_cbranch_scc1 g_st_nosig
    v_mov_b32 v8, 0
    v_mov_b32 v9, 1
    s_mov_b64 exec, 1
    global_atomic_add v8, v9, s[14:15] sc1
    s_mov_b64 exec, -1
g_st_nosig:
    s_lshr_b32 s50, s2, 3
    s_mul_i32 s50, s50, 112
    s_mul_i32 s51, s44, 28
    s_add_u32 s50, s50, s51
    s_lshl_b32 s50, s50, 12
    s_add_u32 s50, s50, 12582912
    s_add_u32 s16, s12, s50
    s_addc_u32 s17, s13, 0
    s_mov_b32 s18, 114688
    s_mov_b32 s19, 131072
    s_mov_b32 s51, 0
    s_movk_i32 s53, 56
g_touch:
    buffer_load_dwordx4 v[128:131], v2, s[16:19], s51 offen
    s_add_u32 s51, s51, 2048
    s_sub_u32 s53, s53, 1
    s_cmp_lg_u32 s53, 0
    s_cbranch_scc1 g_touch
    s_mul_i32 s58, s41, 56
    s_mul_i32 s59, s44, 14
    s_add_u32 s58, s58, s59
    s_lshl_b32 s58, s58, 12
    s_add_u32 s58, s58, 12582912
    s_add_u32 s72, s12, s58
    s_addc_u32 s73, s13, 0
    s_mov_b32 s74, 57344
    s_mov_b32 s75, 131072
    s_mov_b32 s57, 0
    buffer_load_dwordx4 a[0:3], v2, s[72:75], s57 offen offset:0
    buffer_load_dwordx4 a[4:7], v2, s[72:75], s57 offen offset:1024
    buffer_load_dwordx4 a[8:11], v2, s[72:75], s57 offen offset:2048
    buffer_load_dwordx4 a[12:15], v2, s[72:75], s57 offen offset:3072
    s_mov_b32 s57, 4096
    buffer_load_dwordx4 a[16:19], v2, s[72:75], s57 offen offset:0
    buffer_load_dwordx4 a[20:23], v2, s[72:75], s57 offen offset:1024
    buffer_load_dwordx4 a[24:27], v2, s[72:75], s57 offen offset:2048
    buffer_load_dwordx4 a[28:31], v2, s[72:75], s57 offen offset:3072
    s_mov_b32 s57, 8192
    buffer_load_dwordx4 a[32:35], v2, s[72:75], s57 offen offset:0
    buffer_load_dwordx4 a[36:39], v2, s[72:75], s57 offen offset:1024
    buffer_load_dwordx4 a[40:43], v2, s[72:75], s57 offen offset:2048
    buffer_load_dwordx4 a[44:47], v2, s[72:75], s57 offen offset:3072
    s_mov_b32 s57, 12288
    buffer_load_dwordx4 a[48:51], v2, s[72:75], s57 offen offset:0
    buffer_load_dwordx4 a[52:55], v2, s[72:75], s57 offen offset:1024
    buffer_load_dwordx4 a[56:59], v2, s[72:75], s57 offen offset:2048
    buffer_load_dwordx4 a[60:63], v2, s[72:75], s57 offen offset:3072
    s_mov_b32 s57, 16384
    buffer_load_dwordx4 a[64:67], v2, s[72:75], s57 offen offset:0
    buffer_load_dwordx4 a[68:71], v2, s[72:75], s57 offen offset:1024
    buffer_load_dwordx4 a[72:75], v2, s[72:75], s57 offen offset:2048
    buffer_load_dwordx4 a[76:79], v2, s[72:75], s57 offen offset:3072
    s_mov_b32 s57, 20480
    buffer_load_dwordx4 a[80:83], v2, s[72:75], s57 offen offset:0
    buffer_load_dwordx4 a[84:87], v2, s[72:75], s57 offen offset:1024
    buffer_load_dwordx4 a[88:91], v2, s[72:75], s57 offen offset:2048
    buffer_load_dwordx4 a[92:95], v2, s[72:75], s57 offen offset:3072
    s_mov_b32 s57, 24576
    buffer_load_dwordx4 a[96:99], v2, s[72:75], s57 offen offset:0
    buffer_load_dwordx4 a[100:103], v2, s[72:75], s57 offen offset:1024
    buffer_load_dwordx4 a[104:107], v2, s[72:75], s57 offen offset:2048
    buffer_load_dwordx4 a[108:111], v2, s[72:75], s57 offen offset:3072
    s_branch g_part2
g_end:
    s_endpgm
.fill 16, 4, 0xBF800000
code_end:
.fill 16, 4, 0xBF800000
.section .rodata,"a"
.p2align 6
.amdhsa_kernel a_kernel
  .amdhsa_next_free_vgpr 256
  .amdhsa_next_free_sgpr 76
  .amdhsa_accum_offset 256
  .amdhsa_group_segment_fixed_size 0
  .amdhsa_kernarg_size 104
  .amdhsa_user_sgpr_count 2
  .amdhsa_user_sgpr_kernarg_segment_ptr 1
  .amdhsa_system_sgpr_workgroup_id_x 1
  .amdhsa_float_denorm_mode_32 3
.end_amdhsa_kernel
.p2align 6
.amdhsa_kernel g_kernel
  .amdhsa_next_free_vgpr 512
  .amdhsa_next_free_sgpr 96
  .amdhsa_accum_offset 256
  .amdhsa_group_segment_fixed_size 0
  .amdhsa_kernarg_size 104
  .amdhsa_user_sgpr_count 2
  .amdhsa_user_sgpr_kernarg_segment_ptr 1
  .amdhsa_system_sgpr_workgroup_id_x 1
  .amdhsa_float_denorm_mode_32 3
.end_amdhsa_kernel
```
